```python
import torch

def _softmax(x, axis=-1):
    return torch.softmax(x, dim=axis)
def _gelu(x):
    return torch.nn.functional.gelu(x, approximate="tanh")
def _silu(x):
    return torch.nn.functional.silu(x)
def _sigmoid(x):
    return torch.sigmoid(x)
def _layernorm(x, axis=-1, eps=1e-5):
    m = x.mean(dim=axis, keepdim=True)
    v = x.var(dim=axis, keepdim=True, unbiased=False)
    return (x - m) / torch.sqrt(v + eps)
def _scatter_add(tgt, idx, src, axis=0):
    return tgt.clone().index_add_(axis, idx, src)
def _segment_sum(src, seg, n):
    out = torch.zeros((n,) + src.shape[1:], dtype=src.dtype)
    return out.index_add_(0, seg, src)
def _pad(x, pw):
    flat = tuple(v for pair in reversed(pw) for v in pair)
    return torch.nn.functional.pad(x, flat)

kernel_name = 'concat_heads__gqa_block_cached__gqa_block_cached__near_ridge'

def setup_inputs():

    _w = (lambda a: (lambda t: t.to(torch.bfloat16) if t.is_floating_point() else t)(torch.as_tensor(a)))
    def _A_setup():
        B, Sq, D = 8, 32, 512
        Hq, Hkv, Sk, Dh = 32, 8, 2048, 128
        assert Hq % Hkv == 0, (Hq, Hkv)
        return {
            "x": _w((lambda *s: torch.randn(*s, dtype=torch.bfloat16) * 0.8)(B, Sq, D)),
            "k_cache": _w((lambda *s: torch.randn(*s, dtype=torch.bfloat16) * 0.8)(B, Hkv, Sk, Dh)),
            "v_cache": _w((lambda *s: torch.randn(*s, dtype=torch.bfloat16) * 0.05)(B, Hkv, Sk, Dh)),
            "wq": _w((lambda *s: torch.randn(*s, dtype=torch.bfloat16) * 0.8)(D, Hq * Dh) * (D ** -0.5)),
            "wo": _w((lambda *s: torch.randn(*s, dtype=torch.bfloat16) * 0.05)(Hq * Dh, D) * ((Hq * Dh) ** -0.5)),
        }
    _A_in = _A_setup()

    def _B_setup():
        B, Sq, D = 8, 32, 512
        Hq, Hkv, Sk, Dh = 32, 8, 2048, 128
        assert Hq % Hkv == 0, (Hq, Hkv)
        return {
            "x": _w((lambda *s: torch.randn(*s, dtype=torch.bfloat16) * 0.8)(B, Sq, D)),
            "k_cache": _w((lambda *s: torch.randn(*s, dtype=torch.bfloat16) * 0.8)(B, Hkv, Sk, Dh)),
            "v_cache": _w((lambda *s: torch.randn(*s, dtype=torch.bfloat16) * 0.05)(B, Hkv, Sk, Dh)),
            "wq": _w((lambda *s: torch.randn(*s, dtype=torch.bfloat16) * 0.8)(D, Hq * Dh) * (D ** -0.5)),
            "wo": _w((lambda *s: torch.randn(*s, dtype=torch.bfloat16) * 0.05)(Hq * Dh, D) * ((Hq * Dh) ** -0.5)),
        }
    _B_in = _B_setup()

    return {
        "A_x": _A_in["x"],
        "A_k_cache": _A_in["k_cache"],
        "A_v_cache": _A_in["v_cache"],
        "A_wq": _A_in["wq"],
        "A_wo": _A_in["wo"],
        "B_x": _B_in["x"],
        "B_k_cache": _B_in["k_cache"],
        "B_v_cache": _B_in["v_cache"],
        "B_wq": _B_in["wq"],
        "B_wo": _B_in["wo"],
    }

def reference(A_x, A_k_cache, A_v_cache, A_wq, A_wo, B_x, B_k_cache, B_v_cache, B_wq, B_wo):
    def _A_ref(x, k_cache, v_cache, wq, wo):
        B, Sq, D = x.shape
        Hq, Dh = 32, 128
        Hkv = k_cache.shape[1]
        rep = Hq // Hkv
        q = (lambda x, *d: x.permute(*d))((x @ wq).reshape(B, Sq, Hq, Dh), 0, 2, 1, 3)
        k = (lambda x, n, axis: torch.repeat_interleave(x, n, dim=axis))(k_cache, rep, axis=1)
        v = (lambda x, n, axis: torch.repeat_interleave(x, n, dim=axis))(v_cache, rep, axis=1)
        scores = torch.einsum("bhqd,bhkd->bhqk", q, k) * (Dh ** -0.5)
        p = _softmax(scores, axis=-1)
        o = torch.einsum("bhqk,bhkd->bhqd", p, v)
        return (lambda x, *d: x.permute(*d))(o, 0, 2, 1, 3).reshape(B, Sq, Hq * Dh) @ wo

    def _B_ref(x, k_cache, v_cache, wq, wo):
        B, Sq, D = x.shape
        Hq, Dh = 32, 128
        Hkv = k_cache.shape[1]
        rep = Hq // Hkv
        q = (lambda x, *d: x.permute(*d))((x @ wq).reshape(B, Sq, Hq, Dh), 0, 2, 1, 3)
        k = (lambda x, n, axis: torch.repeat_interleave(x, n, dim=axis))(k_cache, rep, axis=1)
        v = (lambda x, n, axis: torch.repeat_interleave(x, n, dim=axis))(v_cache, rep, axis=1)
        scores = torch.einsum("bhqd,bhkd->bhqk", q, k) * (Dh ** -0.5)
        p = _softmax(scores, axis=-1)
        o = torch.einsum("bhqk,bhkd->bhqd", p, v)
        return (lambda x, *d: x.permute(*d))(o, 0, 2, 1, 3).reshape(B, Sq, Hq * Dh) @ wo

    a = _A_ref(A_x, A_k_cache, A_v_cache, A_wq, A_wo)
    b = _B_ref(B_x, B_k_cache, B_v_cache, B_wq, B_wo)
    return torch.concatenate([a, b], axis=-1)
```

```asm
; @launch grid=(256,1,1) block=(512,1,1) lds=163840
.amdgcn_target "amdgcn-amd-amdhsa--gfx950"
.text
.globl concat_heads__gqa_block_cached__gqa_block_cached__near_ridge_kernel
.p2align 8
.type concat_heads__gqa_block_cached__gqa_block_cached__near_ridge_kernel,@function
concat_heads__gqa_block_cached__gqa_block_cached__near_ridge_kernel:
    s_cmp_ge_u32 s2, 256
    s_cbranch_scc1 L_END
    s_load_dwordx16 s[16:31], s[0:1], 0
    s_load_dwordx8 s[32:39], s[0:1], 64
    s_load_dwordx2 s[40:41], s[0:1], 96
    v_and_b32 v1, 63, v0
    v_lshrrev_b32 v9, 6, v0
    v_and_b32 v2, 15, v0
    v_readfirstlane_b32 s3, v9
    v_bfe_u32 v3, v0, 4, 2
    v_bfe_u32 v4, v0, 5, 1
    v_and_b32 v5, 31, v0
    v_bfe_u32 v6, v0, 2, 2
    v_bfe_u32 v7, v0, 4, 1
    v_and_b32 v8, 3, v0
    s_bfe_u32 s4, s2, 0x10002
    s_and_b32 s5, s2, 3
    s_lshr_b32 s6, s2, 3
    s_and_b32 s14, s6, 1
    s_lshl_b32 s7, s5, 1
    s_add_u32 s7, s7, s14
    s_bfe_u32 s8, s6, 0x30001
    s_lshr_b32 s9, s6, 4
    s_and_b32 s14, s6, 7
    s_lshl_b32 s10, s5, 3
    s_add_u32 s10, s10, s14
    s_lshr_b32 s11, s6, 3
    s_mov_b32 s76, 0x3e0293ee
    s_waitcnt lgkmcnt(0)
    s_cmp_eq_u32 s4, 1
    s_cselect_b64 s[16:17], s[26:27], s[16:17]
    s_cselect_b64 s[18:19], s[28:29], s[18:19]
    s_cselect_b64 s[20:21], s[30:31], s[20:21]
    s_cselect_b64 s[22:23], s[32:33], s[22:23]
    s_cselect_b64 s[24:25], s[34:35], s[24:25]
    s_lshl_b32 s14, s11, 16
    s_add_u32 s44, s16, s14
    s_addc_u32 s45, s17, 0
    s_and_b32 s45, s45, 0xffff
    s_mov_b32 s46, 0x10000
    s_mov_b32 s47, 0x00020000
    s_lshl_b32 s14, s10, 8
    s_sub_u32 s15, 0x400000, s14
    s_add_u32 s48, s22, s14
    s_addc_u32 s49, s23, 0
    s_and_b32 s49, s49, 0xffff
    s_mov_b32 s50, s15
    s_mov_b32 s51, 0x00020000
    s_lshl_b32 s14, s8, 3
    s_add_u32 s14, s14, s7
    s_lshl_b32 s14, s14, 1
    s_add_u32 s14, s14, s9
    s_lshl_b32 s14, s14, 18
    s_add_u32 s52, s18, s14
    s_addc_u32 s53, s19, 0
    s_and_b32 s53, s53, 0xffff
    s_mov_b32 s54, 0x40000
    s_mov_b32 s55, 0x00020000
    s_add_u32 s56, s20, s14
    s_addc_u32 s57, s21, 0
    s_and_b32 s57, s57, 0xffff
    s_mov_b32 s58, 0x40000
    s_mov_b32 s59, 0x00020000
    s_lshl_b32 s14, s7, 19
    s_lshl_b32 s15, s9, 9
    s_add_u32 s14, s14, s15
    s_sub_u32 s15, 0x80000, s15
    s_add_u32 s60, s24, s14
    s_addc_u32 s61, s25, 0
    s_and_b32 s61, s61, 0xffff
    s_mov_b32 s62, s15
    s_mov_b32 s63, 0x00020000
    s_mov_b32 s64, s40
    s_mov_b32 s65, s41
    s_and_b32 s65, s65, 0xffff
    s_mov_b32 s66, 0x2800000
    s_mov_b32 s67, 0x00020000
    s_mov_b32 s68, s36
    s_mov_b32 s69, s37
    s_and_b32 s69, s69, 0xffff
    s_mov_b32 s70, 0x80000
    s_mov_b32 s71, 0x00020000
    s_and_b32 s78, s3, 3
    s_lshr_b32 s79, s3, 2
    v_xor_b32 v9, v2, v3
    s_lshl_b32 s14, s3, 1
    s_and_b32 s14, s14, 3
    s_lshl_b32 s14, s14, 2
    v_xor_b32 v10, s14, v9
    v_xor_b32 v11, 4, v10
    v_lshlrev_b32 v12, 10, v3
    v_lshl_add_u32 v16, v10, 4, v12
    v_lshl_add_u32 v17, v11, 4, v12
    v_lshlrev_b32 v9, 2, v3
    v_xor_b32 v9, v9, v2
    v_lshlrev_b32 v12, 13, v3
    v_lshl_add_u32 v18, v9, 4, v12
    s_lshl_b32 s14, s3, 11
    s_add_u32 s14, s14, 0
    s_mov_b32 m0, s14
    s_lshl_b32 s15, s3, 13
    s_add_u32 s15, s15, 0
    buffer_load_dwordx4 v16, s[44:47], s15 offen nt lds
    s_lshl_b32 s14, s3, 11
    s_add_u32 s14, s14, 1024
    s_mov_b32 m0, s14
    s_lshl_b32 s15, s3, 13
    s_add_u32 s15, s15, 4096
    buffer_load_dwordx4 v17, s[44:47], s15 offen nt lds
    s_lshl_b32 s14, s3, 12
    s_add_u32 s14, s14, 49152
    s_mov_b32 m0, s14
    s_lshl_b32 s15, s3, 17
    s_add_u32 s42, s15, 0
    buffer_load_dwordx4 v18, s[48:51], s42 offen offset:0 nt lds
    s_add_u32 s42, s15, 31744
    buffer_load_dwordx4 v18, s[48:51], s42 offen offset:1024 nt lds
    s_add_u32 s42, s15, 63488
    buffer_load_dwordx4 v18, s[48:51], s42 offen offset:2048 nt lds
    s_add_u32 s42, s15, 95232
    buffer_load_dwordx4 v18, s[48:51], s42 offen offset:3072 nt lds
    s_lshl_b32 s14, s3, 11
    s_add_u32 s14, s14, 16384
    s_mov_b32 m0, s14
    s_lshl_b32 s15, s3, 13
    s_add_u32 s15, s15, 256
    buffer_load_dwordx4 v16, s[44:47], s15 offen nt lds
    s_lshl_b32 s14, s3, 11
    s_add_u32 s14, s14, 17408
    s_mov_b32 m0, s14
    s_lshl_b32 s15, s3, 13
    s_add_u32 s15, s15, 4352
    buffer_load_dwordx4 v17, s[44:47], s15 offen nt lds
    s_lshl_b32 s14, s3, 12
    s_add_u32 s14, s14, 81920
    s_mov_b32 m0, s14
    s_lshl_b32 s15, s3, 17
    s_add_u32 s42, s15, 1048576
    buffer_load_dwordx4 v18, s[48:51], s42 offen offset:0 nt lds
    s_add_u32 s42, s15, 1080320
    buffer_load_dwordx4 v18, s[48:51], s42 offen offset:1024 nt lds
    s_add_u32 s42, s15, 1112064
    buffer_load_dwordx4 v18, s[48:51], s42 offen offset:2048 nt lds
    s_add_u32 s42, s15, 1143808
    buffer_load_dwordx4 v18, s[48:51], s42 offen offset:3072 nt lds
    s_lshl_b32 s14, s3, 11
    s_add_u32 s14, s14, 32768
    s_mov_b32 m0, s14
    s_lshl_b32 s15, s3, 13
    s_add_u32 s15, s15, 512
    buffer_load_dwordx4 v16, s[44:47], s15 offen nt lds
    s_lshl_b32 s14, s3, 11
    s_add_u32 s14, s14, 33792
    s_mov_b32 m0, s14
    s_lshl_b32 s15, s3, 13
    s_add_u32 s15, s15, 4608
    buffer_load_dwordx4 v17, s[44:47], s15 offen nt lds
    s_lshl_b32 s14, s3, 12
    s_add_u32 s14, s14, 114688
    s_mov_b32 m0, s14
    s_lshl_b32 s15, s3, 17
    s_add_u32 s42, s15, 2097152
    buffer_load_dwordx4 v18, s[48:51], s42 offen offset:0 nt lds
    s_add_u32 s42, s15, 2128896
    buffer_load_dwordx4 v18, s[48:51], s42 offen offset:1024 nt lds
    s_add_u32 s42, s15, 2160640
    buffer_load_dwordx4 v18, s[48:51], s42 offen offset:2048 nt lds
    s_add_u32 s42, s15, 2192384
    buffer_load_dwordx4 v18, s[48:51], s42 offen offset:3072 nt lds
    s_cmp_ge_u32 s3, 6
    s_cselect_b32 s72, s56, s52
    s_cselect_b32 s73, s57, s53
    s_cselect_b32 s74, s58, s54
    s_cselect_b32 s75, s59, s55
    s_lshl_b32 s14, s79, 13
    v_lshlrev_b32 v9, 8, v5
    v_add_u32 v9, s14, v9
    v_and_b32 v10, 15, v5
    v_xor_b32 v10, v10, v4
    v_xor_b32 v11, 0, v10
    v_lshl_add_u32 v20, v11, 4, v9
    v_xor_b32 v11, 2, v10
    v_lshl_add_u32 v21, v11, 4, v9
    v_xor_b32 v11, 4, v10
    v_lshl_add_u32 v22, v11, 4, v9
    v_xor_b32 v11, 6, v10
    v_lshl_add_u32 v23, v11, 4, v9
    v_xor_b32 v11, 8, v10
    v_lshl_add_u32 v24, v11, 4, v9
    v_xor_b32 v11, 10, v10
    v_lshl_add_u32 v25, v11, 4, v9
    v_xor_b32 v11, 12, v10
    v_lshl_add_u32 v26, v11, 4, v9
    v_xor_b32 v11, 14, v10
    v_lshl_add_u32 v27, v11, 4, v9
    v_lshl_add_u32 v9, v4, 3, v6
    v_lshlrev_b32 v9, 8, v9
    v_xor_b32 v10, s78, v6
    v_lshl_add_u32 v9, v10, 6, v9
    v_lshl_add_u32 v9, v7, 5, v9
    v_lshl_add_u32 v9, v8, 3, v9
    v_add_u32 v28, 49152, v9
    v_add_u32 v29, 81920, v9
    v_add_u32 v30, 114688, v9
    s_and_b32 s14, s3, 1
    s_lshl_b32 s14, s14, 13
    v_lshlrev_b32 v19, 7, v1
    v_add_u32 v19, s14, v19
    s_cmp_lt_u32 s3, 4
    s_cbranch_scc1 NOHELP_1
    s_cmp_lg_u32 s3, 7
    s_cbranch_scc1 NOHELP_1
    s_cmp_lg_u32 s2, 0
    s_cbranch_scc1 NOHELP_1
    v_mov_b32 v9, 0
    s_memrealtime s[14:15]
    s_waitcnt lgkmcnt(0)
    s_or_b32 s14, s14, 1
    v_mov_b32 v10, s14
    v_mov_b32 v11, s15
    s_mov_b64 exec, 1
    global_store_dwordx2 v9, v[10:11], s[38:39] sc0 sc1
    s_mov_b64 exec, -1
NOHELP_1:
    s_waitcnt vmcnt(12)
    s_barrier
    ds_read_b128 v[48:51], v20 offset:0
    ds_read_b64_tr_b16 v[80:81], v28 offset:0
    ds_read_b64_tr_b16 v[82:83], v28 offset:1024
    ds_read_b128 v[52:55], v21 offset:0
    ds_read_b64_tr_b16 v[84:85], v28 offset:4096
    ds_read_b64_tr_b16 v[86:87], v28 offset:5120
    ds_read_b128 v[56:59], v22 offset:0
    ds_read_b64_tr_b16 v[88:89], v28 offset:8192
    ds_read_b64_tr_b16 v[90:91], v28 offset:9216
    ds_read_b128 v[60:63], v23 offset:0
    ds_read_b64_tr_b16 v[92:93], v28 offset:12288
    ds_read_b64_tr_b16 v[94:95], v28 offset:13312
    s_waitcnt lgkmcnt(9)
    v_mfma_f32_32x32x16_bf16 v[32:47], v[80:83], v[48:51], 0
    s_waitcnt lgkmcnt(6)
    v_mfma_f32_32x32x16_bf16 v[32:47], v[84:87], v[52:55], v[32:47]
    s_waitcnt lgkmcnt(3)
    v_mfma_f32_32x32x16_bf16 v[32:47], v[88:91], v[56:59], v[32:47]
    s_waitcnt lgkmcnt(0)
    v_mfma_f32_32x32x16_bf16 v[32:47], v[92:95], v[60:63], v[32:47]
    ds_read_b128 v[64:67], v24 offset:0
    ds_read_b64_tr_b16 v[96:97], v28 offset:16384
    ds_read_b64_tr_b16 v[98:99], v28 offset:17408
    ds_read_b128 v[68:71], v25 offset:0
    ds_read_b64_tr_b16 v[100:101], v28 offset:20480
    ds_read_b64_tr_b16 v[102:103], v28 offset:21504
    ds_read_b128 v[72:75], v26 offset:0
    ds_read_b64_tr_b16 v[104:105], v28 offset:24576
    ds_read_b64_tr_b16 v[106:107], v28 offset:25600
    ds_read_b128 v[76:79], v27 offset:0
    ds_read_b64_tr_b16 v[108:109], v28 offset:28672
    ds_read_b64_tr_b16 v[110:111], v28 offset:29696
    s_waitcnt lgkmcnt(9)
    v_mfma_f32_32x32x16_bf16 v[32:47], v[96:99], v[64:67], v[32:47]
    s_waitcnt lgkmcnt(6)
    v_mfma_f32_32x32x16_bf16 v[32:47], v[100:103], v[68:71], v[32:47]
    s_waitcnt lgkmcnt(3)
    v_mfma_f32_32x32x16_bf16 v[32:47], v[104:107], v[72:75], v[32:47]
    s_waitcnt lgkmcnt(0)
    v_mfma_f32_32x32x16_bf16 v[32:47], v[108:111], v[76:79], v[32:47]
    s_waitcnt vmcnt(6)
    s_barrier
    s_lshl_b32 s14, s3, 11
    s_add_u32 s14, s14, 0
    s_mov_b32 m0, s14
    s_lshl_b32 s15, s3, 13
    s_add_u32 s15, s15, 768
    buffer_load_dwordx4 v16, s[44:47], s15 offen nt lds
    s_lshl_b32 s14, s3, 11
    s_add_u32 s14, s14, 1024
    s_mov_b32 m0, s14
    s_lshl_b32 s15, s3, 13
    s_add_u32 s15, s15, 4864
    buffer_load_dwordx4 v17, s[44:47], s15 offen nt lds
    s_lshl_b32 s14, s3, 12
    s_add_u32 s14, s14, 49152
    s_mov_b32 m0, s14
    s_lshl_b32 s15, s3, 17
    s_add_u32 s42, s15, 3145728
    buffer_load_dwordx4 v18, s[48:51], s42 offen offset:0 nt lds
    s_add_u32 s42, s15, 3177472
    buffer_load_dwordx4 v18, s[48:51], s42 offen offset:1024 nt lds
    s_add_u32 s42, s15, 3209216
    buffer_load_dwordx4 v18, s[48:51], s42 offen offset:2048 nt lds
    s_add_u32 s42, s15, 3240960
    buffer_load_dwordx4 v18, s[48:51], s42 offen offset:3072 nt lds
    ds_read_b128 v[48:51], v20 offset:16384
    ds_read_b64_tr_b16 v[80:81], v29 offset:0
    ds_read_b64_tr_b16 v[82:83], v29 offset:1024
    ds_read_b128 v[52:55], v21 offset:16384
    ds_read_b64_tr_b16 v[84:85], v29 offset:4096
    ds_read_b64_tr_b16 v[86:87], v29 offset:5120
    ds_read_b128 v[56:59], v22 offset:16384
    ds_read_b64_tr_b16 v[88:89], v29 offset:8192
    ds_read_b64_tr_b16 v[90:91], v29 offset:9216
    ds_read_b128 v[60:63], v23 offset:16384
    ds_read_b64_tr_b16 v[92:93], v29 offset:12288
    ds_read_b64_tr_b16 v[94:95], v29 offset:13312
    s_waitcnt lgkmcnt(9)
    v_mfma_f32_32x32x16_bf16 v[32:47], v[80:83], v[48:51], v[32:47]
    s_waitcnt lgkmcnt(6)
    v_mfma_f32_32x32x16_bf16 v[32:47], v[84:87], v[52:55], v[32:47]
    s_waitcnt lgkmcnt(3)
    v_mfma_f32_32x32x16_bf16 v[32:47], v[88:91], v[56:59], v[32:47]
    s_waitcnt lgkmcnt(0)
    v_mfma_f32_32x32x16_bf16 v[32:47], v[92:95], v[60:63], v[32:47]
    ds_read_b128 v[64:67], v24 offset:16384
    ds_read_b64_tr_b16 v[96:97], v29 offset:16384
    ds_read_b64_tr_b16 v[98:99], v29 offset:17408
    ds_read_b128 v[68:71], v25 offset:16384
    ds_read_b64_tr_b16 v[100:101], v29 offset:20480
    ds_read_b64_tr_b16 v[102:103], v29 offset:21504
    ds_read_b128 v[72:75], v26 offset:16384
    ds_read_b64_tr_b16 v[104:105], v29 offset:24576
    ds_read_b64_tr_b16 v[106:107], v29 offset:25600
    ds_read_b128 v[76:79], v27 offset:16384
    ds_read_b64_tr_b16 v[108:109], v29 offset:28672
    ds_read_b64_tr_b16 v[110:111], v29 offset:29696
    s_waitcnt lgkmcnt(9)
    v_mfma_f32_32x32x16_bf16 v[32:47], v[96:99], v[64:67], v[32:47]
    s_waitcnt lgkmcnt(6)
    v_mfma_f32_32x32x16_bf16 v[32:47], v[100:103], v[68:71], v[32:47]
    s_waitcnt lgkmcnt(3)
    v_mfma_f32_32x32x16_bf16 v[32:47], v[104:107], v[72:75], v[32:47]
    s_waitcnt lgkmcnt(0)
    v_mfma_f32_32x32x16_bf16 v[32:47], v[108:111], v[76:79], v[32:47]
    s_waitcnt vmcnt(6)
    s_barrier
    ds_read_b128 v[48:51], v20 offset:32768
    ds_read_b64_tr_b16 v[80:81], v30 offset:0
    ds_read_b64_tr_b16 v[82:83], v30 offset:1024
    ds_read_b128 v[52:55], v21 offset:32768
    ds_read_b64_tr_b16 v[84:85], v30 offset:4096
    ds_read_b64_tr_b16 v[86:87], v30 offset:5120
    ds_read_b128 v[56:59], v22 offset:32768
    ds_read_b64_tr_b16 v[88:89], v30 offset:8192
    ds_read_b64_tr_b16 v[90:91], v30 offset:9216
    ds_read_b128 v[60:63], v23 offset:32768
    ds_read_b64_tr_b16 v[92:93], v30 offset:12288
    ds_read_b64_tr_b16 v[94:95], v30 offset:13312
    s_waitcnt lgkmcnt(9)
    v_mfma_f32_32x32x16_bf16 v[32:47], v[80:83], v[48:51], v[32:47]
    s_waitcnt lgkmcnt(6)
    v_mfma_f32_32x32x16_bf16 v[32:47], v[84:87], v[52:55], v[32:47]
    s_waitcnt lgkmcnt(3)
    v_mfma_f32_32x32x16_bf16 v[32:47], v[88:91], v[56:59], v[32:47]
    s_waitcnt lgkmcnt(0)
    v_mfma_f32_32x32x16_bf16 v[32:47], v[92:95], v[60:63], v[32:47]
    ds_read_b128 v[64:67], v24 offset:32768
    ds_read_b64_tr_b16 v[96:97], v30 offset:16384
    ds_read_b64_tr_b16 v[98:99], v30 offset:17408
    ds_read_b128 v[68:71], v25 offset:32768
    ds_read_b64_tr_b16 v[100:101], v30 offset:20480
    ds_read_b64_tr_b16 v[102:103], v30 offset:21504
    ds_read_b128 v[72:75], v26 offset:32768
    ds_read_b64_tr_b16 v[104:105], v30 offset:24576
    ds_read_b64_tr_b16 v[106:107], v30 offset:25600
    ds_read_b128 v[76:79], v27 offset:32768
    ds_read_b64_tr_b16 v[108:109], v30 offset:28672
    ds_read_b64_tr_b16 v[110:111], v30 offset:29696
    s_waitcnt lgkmcnt(9)
    v_mfma_f32_32x32x16_bf16 v[32:47], v[96:99], v[64:67], v[32:47]
    s_waitcnt lgkmcnt(6)
    v_mfma_f32_32x32x16_bf16 v[32:47], v[100:103], v[68:71], v[32:47]
    s_waitcnt lgkmcnt(3)
    v_mfma_f32_32x32x16_bf16 v[32:47], v[104:107], v[72:75], v[32:47]
    s_waitcnt lgkmcnt(0)
    v_mfma_f32_32x32x16_bf16 v[32:47], v[108:111], v[76:79], v[32:47]
    s_waitcnt vmcnt(0)
    s_barrier
    ds_read_b128 v[48:51], v20 offset:0
    ds_read_b64_tr_b16 v[80:81], v28 offset:0
    ds_read_b64_tr_b16 v[82:83], v28 offset:1024
    ds_read_b128 v[52:55], v21 offset:0
    ds_read_b64_tr_b16 v[84:85], v28 offset:4096
    ds_read_b64_tr_b16 v[86:87], v28 offset:5120
    ds_read_b128 v[56:59], v22 offset:0
    ds_read_b64_tr_b16 v[88:89], v28 offset:8192
    ds_read_b64_tr_b16 v[90:91], v28 offset:9216
    ds_read_b128 v[60:63], v23 offset:0
    ds_read_b64_tr_b16 v[92:93], v28 offset:12288
    ds_read_b64_tr_b16 v[94:95], v28 offset:13312
    s_waitcnt lgkmcnt(9)
    v_mfma_f32_32x32x16_bf16 v[32:47], v[80:83], v[48:51], v[32:47]
    s_waitcnt lgkmcnt(6)
    v_mfma_f32_32x32x16_bf16 v[32:47], v[84:87], v[52:55], v[32:47]
    s_waitcnt lgkmcnt(3)
    v_mfma_f32_32x32x16_bf16 v[32:47], v[88:91], v[56:59], v[32:47]
    s_waitcnt lgkmcnt(0)
    v_mfma_f32_32x32x16_bf16 v[32:47], v[92:95], v[60:63], v[32:47]
    ds_read_b128 v[64:67], v24 offset:0
    ds_read_b64_tr_b16 v[96:97], v28 offset:16384
    ds_read_b64_tr_b16 v[98:99], v28 offset:17408
    ds_read_b128 v[68:71], v25 offset:0
    ds_read_b64_tr_b16 v[100:101], v28 offset:20480
    ds_read_b64_tr_b16 v[102:103], v28 offset:21504
    ds_read_b128 v[72:75], v26 offset:0
    ds_read_b64_tr_b16 v[104:105], v28 offset:24576
    ds_read_b64_tr_b16 v[106:107], v28 offset:25600
    ds_read_b128 v[76:79], v27 offset:0
    ds_read_b64_tr_b16 v[108:109], v28 offset:28672
    ds_read_b64_tr_b16 v[110:111], v28 offset:29696
    s_waitcnt lgkmcnt(9)
    v_mfma_f32_32x32x16_bf16 v[32:47], v[96:99], v[64:67], v[32:47]
    s_waitcnt lgkmcnt(6)
    v_mfma_f32_32x32x16_bf16 v[32:47], v[100:103], v[68:71], v[32:47]
    s_waitcnt lgkmcnt(3)
    v_mfma_f32_32x32x16_bf16 v[32:47], v[104:107], v[72:75], v[32:47]
    s_waitcnt lgkmcnt(0)
    v_mfma_f32_32x32x16_bf16 v[32:47], v[108:111], v[76:79], v[32:47]
    s_cmp_lg_u32 s3, 7
    s_cbranch_scc1 NOT7_2
    v_mov_b32 v9, 0
    s_mov_b32 s77, 0
NPOLL_3:
    global_load_dwordx2 v[10:11], v9, s[38:39] sc0 sc1
    s_waitcnt vmcnt(0)
    v_cmp_eq_u32 vcc, 0, v10
    s_add_u32 s77, s77, 1
    s_nop 1
    s_cbranch_vccz NPOLLD_4
    s_sleep 2
    s_cmp_lt_u32 s77, 400000
    s_cbranch_scc1 NPOLL_3
NPOLLD_4:
    v_mov_b32 v9, 147456
    ds_write_b64 v9, v[10:11]
    s_waitcnt lgkmcnt(0)
NOT7_2:
    s_nop 15
    v_cvt_pk_bf16_f32 v112, v32, v33
    v_cvt_pk_bf16_f32 v113, v34, v35
    v_cvt_pk_bf16_f32 v114, v36, v37
    v_cvt_pk_bf16_f32 v115, v38, v39
    v_cvt_pk_bf16_f32 v116, v40, v41
    v_cvt_pk_bf16_f32 v117, v42, v43
    v_cvt_pk_bf16_f32 v118, v44, v45
    v_cvt_pk_bf16_f32 v119, v46, v47
    s_nop 1
    v_permlane32_swap_b32 v112, v114
    v_permlane32_swap_b32 v113, v115
    v_permlane32_swap_b32 v116, v118
    v_permlane32_swap_b32 v117, v119
    s_lshl_b32 s14, s4, 3
    s_lshl_b32 s15, s11, 1
    s_add_u32 s14, s14, s15
    s_add_u32 s14, s14, s79
    s_lshl_b32 s14, s14, 5
    s_add_u32 s14, s14, s10
    s_lshl_b32 s14, s14, 13
    s_lshl_b32 s15, s78, 11
    s_add_u32 s14, s14, s15
    v_lshlrev_b32 v9, 4, v1
    buffer_store_dwordx4 v[112:115], v9, s[64:67], s14 offen offset:0 sc0 sc1
    buffer_store_dwordx4 v[116:119], v9, s[64:67], s14 offen offset:1024 sc0 sc1
    s_waitcnt vmcnt(0)
    s_barrier
    v_mov_b32 v9, 147456
    ds_read_b64 v[10:11], v9
    s_waitcnt lgkmcnt(0)
    s_nop 0
    v_readfirstlane_b32 s12, v10
    v_readfirstlane_b32 s13, v11
    s_nop 3
    s_cmp_ge_u32 s3, 4
    s_cbranch_scc1 L_HELPER
    s_cmp_lg_u32 s3, 0
    s_cbranch_scc1 NOQF_5
    s_lshl_b32 s14, s2, 8
    s_add_u32 s14, s14, 0x1800000
    v_mov_b32 v9, s14
    v_mov_b32 v10, s12
    v_mov_b32 v11, s13
    s_mov_b64 exec, 0x1
    global_store_dwordx2 v9, v[10:11], s[40:41] sc0 sc1
    s_mov_b64 exec, -1
NOQF_5:
    v_lshlrev_b32 v9, 8, v5
    v_and_b32 v10, 15, v5
    v_xor_b32 v10, v10, v4
    v_xor_b32 v11, 0, v10
    v_lshl_add_u32 v224, v11, 4, v9
    v_xor_b32 v11, 2, v10
    v_lshl_add_u32 v225, v11, 4, v9
    v_xor_b32 v11, 4, v10
    v_lshl_add_u32 v226, v11, 4, v9
    v_xor_b32 v11, 6, v10
    v_lshl_add_u32 v227, v11, 4, v9
    v_xor_b32 v11, 8, v10
    v_lshl_add_u32 v228, v11, 4, v9
    v_xor_b32 v11, 10, v10
    v_lshl_add_u32 v229, v11, 4, v9
    v_xor_b32 v11, 12, v10
    v_lshl_add_u32 v230, v11, 4, v9
    v_xor_b32 v11, 14, v10
    v_lshl_add_u32 v231, v11, 4, v9
    v_lshl_add_u32 v9, v4, 2, v6
    v_lshlrev_b32 v9, 8, v9
    v_lshl_add_u32 v9, v7, 5, v9
    v_lshl_add_u32 v9, v8, 3, v9
    v_add_u32 v9, 49152, v9
    v_xor_b32 v10, 0, v6
    v_lshl_add_u32 v232, v10, 6, v9
    v_xor_b32 v10, 1, v6
    v_lshl_add_u32 v233, v10, 6, v9
    v_xor_b32 v10, 2, v6
    v_lshl_add_u32 v234, v10, 6, v9
    v_xor_b32 v10, 3, v6
    v_lshl_add_u32 v235, v10, 6, v9
    v_mov_b32 v48, 0
    v_mov_b32 v49, 0
    v_mov_b32 v50, 0
    v_mov_b32 v51, 0
    v_mov_b32 v52, 0
    v_mov_b32 v53, 0
    v_mov_b32 v54, 0
    v_mov_b32 v55, 0
    v_mov_b32 v56, 0
    v_mov_b32 v57, 0
    v_mov_b32 v58, 0
    v_mov_b32 v59, 0
    v_mov_b32 v60, 0
    v_mov_b32 v61, 0
    v_mov_b32 v62, 0
    v_mov_b32 v63, 0
    v_mov_b32 v64, 0
    v_mov_b32 v65, 0
    v_mov_b32 v66, 0
    v_mov_b32 v67, 0
    v_mov_b32 v68, 0
    v_mov_b32 v69, 0
    v_mov_b32 v70, 0
    v_mov_b32 v71, 0
    v_mov_b32 v72, 0
    v_mov_b32 v73, 0
    v_mov_b32 v74, 0
    v_mov_b32 v75, 0
    v_mov_b32 v76, 0
    v_mov_b32 v77, 0
    v_mov_b32 v78, 0
    v_mov_b32 v79, 0
    v_mov_b32 v80, 0
    v_mov_b32 v81, 0
    v_mov_b32 v82, 0
    v_mov_b32 v83, 0
    v_mov_b32 v84, 0
    v_mov_b32 v85, 0
    v_mov_b32 v86, 0
    v_mov_b32 v87, 0
    v_mov_b32 v88, 0
    v_mov_b32 v89, 0
    v_mov_b32 v90, 0
    v_mov_b32 v91, 0
    v_mov_b32 v92, 0
    v_mov_b32 v93, 0
    v_mov_b32 v94, 0
    v_mov_b32 v95, 0
    v_mov_b32 v96, 0
    v_mov_b32 v97, 0
    v_mov_b32 v98, 0
    v_mov_b32 v99, 0
    v_mov_b32 v100, 0
    v_mov_b32 v101, 0
    v_mov_b32 v102, 0
    v_mov_b32 v103, 0
    v_mov_b32 v104, 0
    v_mov_b32 v105, 0
    v_mov_b32 v106, 0
    v_mov_b32 v107, 0
    v_mov_b32 v108, 0
    v_mov_b32 v109, 0
    v_mov_b32 v110, 0
    v_mov_b32 v111, 0
    v_mov_b32 v238, 0
    v_mov_b32 v239, 0
    v_mov_b32 v240, 0
    v_mov_b32 v241, 0
    v_mov_b32 v236, 0xf149f2ca
    v_mov_b32 v237, 0xf149f2ca
    s_and_b32 s14, s7, 1
    s_lshl_b32 s14, s14, 2
    s_add_u32 s14, s14, s3
    s_lshr_b32 s15, s8, 1
    s_lshl_b32 s15, s15, 3
    s_or_b32 s14, s14, s15
    s_lshl_b32 s14, s14, 3
    s_and_b32 s15, s2, 7
    s_or_b32 s14, s14, s15
    s_lshl_b32 s14, s14, 8
    s_add_u32 s14, s14, 0x1800000
    v_mov_b32 v9, s14
    s_mov_b64 exec, 0x1
    s_mov_b32 s77, 0
POLL_6:
    global_load_dwordx2 v[10:11], v9, s[40:41] sc0 sc1
    s_waitcnt vmcnt(0)
    v_cmp_ne_u64 vcc, s[12:13], v[10:11]
    s_add_u32 s77, s77, 1
    s_nop 1
    s_cbranch_vccz POLLD_7
    s_cmp_lt_u32 s77, 400000
    s_cbranch_scc1 POLL_6
POLLD_7:
    s_mov_b64 exec, -1
    s_lshl_b32 s14, s4, 3
    s_add_u32 s14, s14, s8
    s_lshl_b32 s14, s14, 5
    s_lshl_b32 s15, s7, 2
    s_add_u32 s14, s14, s15
    s_add_u32 s14, s14, s3
    s_lshl_b32 s14, s14, 13
    s_add_u32 s15, s14, 4096
    v_lshlrev_b32 v9, 4, v1
    buffer_load_dwordx4 v[16:19], v9, s[64:67], s14 offen offset:0 sc0 sc1
    buffer_load_dwordx4 v[20:23], v9, s[64:67], s14 offen offset:1024 sc0 sc1
    buffer_load_dwordx4 v[24:27], v9, s[64:67], s14 offen offset:2048 sc0 sc1
    buffer_load_dwordx4 v[28:31], v9, s[64:67], s14 offen offset:3072 sc0 sc1
    buffer_load_dwordx4 v[32:35], v9, s[64:67], s15 offen offset:0 sc0 sc1
    buffer_load_dwordx4 v[36:39], v9, s[64:67], s15 offen offset:1024 sc0 sc1
    buffer_load_dwordx4 v[40:43], v9, s[64:67], s15 offen offset:2048 sc0 sc1
    buffer_load_dwordx4 v[44:47], v9, s[64:67], s15 offen offset:3072 sc0 sc1
    s_waitcnt vmcnt(0)
    s_mov_b32 s78, 0
    s_mov_b32 s79, 0
    s_mov_b32 s43, 16384
    s_barrier
    ds_read_b128 v[160:163], v224
    ds_read_b128 v[164:167], v225
    ds_read_b128 v[168:171], v226
    ds_read_b128 v[172:175], v227
    ds_read_b128 v[176:179], v228
    ds_read_b128 v[180:183], v229
    ds_read_b128 v[184:187], v230
    ds_read_b128 v[188:191], v231
L_TILE:
    ds_read_b128 v[192:195], v224 offset:8192
    ds_read_b128 v[196:199], v225 offset:8192
    ds_read_b128 v[200:203], v226 offset:8192
    ds_read_b128 v[204:207], v227 offset:8192
    s_waitcnt lgkmcnt(11)
    v_mfma_f32_32x32x16_bf16 v[112:127], v[160:163], v[16:19], 0
    s_waitcnt lgkmcnt(10)
    v_mfma_f32_32x32x16_bf16 v[112:127], v[164:167], v[20:23], v[112:127]
    ds_read_b128 v[208:211], v228 offset:8192
    s_waitcnt lgkmcnt(10)
    v_mfma_f32_32x32x16_bf16 v[112:127], v[168:171], v[24:27], v[112:127]
    s_waitcnt lgkmcnt(9)
    v_mfma_f32_32x32x16_bf16 v[112:127], v[172:175], v[28:31], v[112:127]
    ds_read_b128 v[212:215], v229 offset:8192
    s_waitcnt lgkmcnt(9)
    v_mfma_f32_32x32x16_bf16 v[112:127], v[176:179], v[32:35], v[112:127]
    s_waitcnt lgkmcnt(8)
    v_mfma_f32_32x32x16_bf16 v[112:127], v[180:183], v[36:39], v[112:127]
    ds_read_b128 v[216:219], v230 offset:8192
    s_waitcnt lgkmcnt(8)
    v_mfma_f32_32x32x16_bf16 v[112:127], v[184:187], v[40:43], v[112:127]
    s_waitcnt lgkmcnt(7)
    v_mfma_f32_32x32x16_bf16 v[112:127], v[188:191], v[44:47], v[112:127]
    ds_read_b128 v[220:223], v231 offset:8192
    s_waitcnt lgkmcnt(7)
    v_mfma_f32_32x32x16_bf16 v[128:143], v[192:195], v[16:19], 0
    ds_read_b64_tr_b16 v[160:161], v232 offset:0
    ds_read_b64_tr_b16 v[162:163], v232 offset:2048
    s_waitcnt lgkmcnt(8)
    v_mfma_f32_32x32x16_bf16 v[128:143], v[196:199], v[20:23], v[128:143]
    ds_read_b64_tr_b16 v[164:165], v233 offset:0
    ds_read_b64_tr_b16 v[166:167], v233 offset:2048
    s_waitcnt lgkmcnt(9)
    v_mfma_f32_32x32x16_bf16 v[128:143], v[200:203], v[24:27], v[128:143]
    ds_read_b64_tr_b16 v[168:169], v234 offset:0
    ds_read_b64_tr_b16 v[170:171], v234 offset:2048
    s_waitcnt lgkmcnt(10)
    v_mfma_f32_32x32x16_bf16 v[128:143], v[204:207], v[28:31], v[128:143]
    ds_read_b64_tr_b16 v[172:173], v235 offset:0
    ds_read_b64_tr_b16 v[174:175], v235 offset:2048
    s_waitcnt lgkmcnt(11)
    v_mfma_f32_32x32x16_bf16 v[128:143], v[208:211], v[32:35], v[128:143]
    ds_read_b64_tr_b16 v[176:177], v232 offset:4096
    ds_read_b64_tr_b16 v[178:179], v232 offset:6144
    v_max3_f32 v242, v112, v113, v114
    v_max3_f32 v243, v115, v116, v117
    s_waitcnt lgkmcnt(12)
    v_mfma_f32_32x32x16_bf16 v[128:143], v[212:215], v[36:39], v[128:143]
    ds_read_b64_tr_b16 v[180:181], v233 offset:4096
    ds_read_b64_tr_b16 v[182:183], v233 offset:6144
    v_max3_f32 v244, v118, v119, v120
    v_max3_f32 v242, v242, v121, v122
    s_waitcnt lgkmcnt(13)
    v_mfma_f32_32x32x16_bf16 v[128:143], v[216:219], v[40:43], v[128:143]
    ds_read_b64_tr_b16 v[184:185], v234 offset:4096
    ds_read_b64_tr_b16 v[186:187], v234 offset:6144
    v_max3_f32 v243, v243, v123, v124
    v_max3_f32 v244, v244, v125, v126
    s_waitcnt lgkmcnt(14)
    v_mfma_f32_32x32x16_bf16 v[128:143], v[220:223], v[44:47], v[128:143]
    ds_read_b64_tr_b16 v[188:189], v235 offset:4096
    s_waitcnt lgkmcnt(14)
    ds_read_b64_tr_b16 v[190:191], v235 offset:6144
    v_max3_f32 v242, v242, v243, v127
    v_max_f32 v242, v242, v244
    s_waitcnt lgkmcnt(14)
    ds_read_b64_tr_b16 v[192:193], v232 offset:8192
    s_waitcnt lgkmcnt(14)
    ds_read_b64_tr_b16 v[194:195], v232 offset:10240
    s_waitcnt lgkmcnt(14)
    ds_read_b64_tr_b16 v[196:197], v233 offset:8192
    s_waitcnt lgkmcnt(14)
    ds_read_b64_tr_b16 v[198:199], v233 offset:10240
    s_waitcnt lgkmcnt(14)
    ds_read_b64_tr_b16 v[200:201], v234 offset:8192
    s_waitcnt lgkmcnt(14)
    ds_read_b64_tr_b16 v[202:203], v234 offset:10240
    s_waitcnt lgkmcnt(14)
    ds_read_b64_tr_b16 v[204:205], v235 offset:8192
    s_waitcnt lgkmcnt(14)
    ds_read_b64_tr_b16 v[206:207], v235 offset:10240
    s_waitcnt lgkmcnt(14)
    ds_read_b64_tr_b16 v[208:209], v232 offset:12288
    s_waitcnt lgkmcnt(14)
    ds_read_b64_tr_b16 v[210:211], v232 offset:14336
    s_waitcnt lgkmcnt(14)
    ds_read_b64_tr_b16 v[212:213], v233 offset:12288
    s_waitcnt lgkmcnt(14)
    ds_read_b64_tr_b16 v[214:215], v233 offset:14336
    s_waitcnt lgkmcnt(14)
    ds_read_b64_tr_b16 v[216:217], v234 offset:12288
    s_waitcnt lgkmcnt(14)
    ds_read_b64_tr_b16 v[218:219], v234 offset:14336
    s_waitcnt lgkmcnt(14)
    ds_read_b64_tr_b16 v[220:221], v235 offset:12288
    s_waitcnt lgkmcnt(14)
    ds_read_b64_tr_b16 v[222:223], v235 offset:14336
    s_nop 3
    v_max3_f32 v244, v128, v129, v130
    v_max3_f32 v245, v131, v132, v133
    v_max3_f32 v246, v134, v135, v136
    v_max3_f32 v244, v244, v137, v138
    v_max3_f32 v245, v245, v139, v140
    v_max3_f32 v246, v246, v141, v142
    v_max3_f32 v244, v244, v245, v143
    v_max_f32 v244, v244, v246
    v_max_f32 v242, v242, v244
    v_mov_b32 v243, v242
    s_nop 1
    v_permlane32_swap_b32 v242, v243
    s_nop 0
    v_max_f32 v242, v242, v243
    v_mul_f32 v242, s76, v242
    v_cmp_gt_f32 vcc, v242, v237
    s_nop 1
    s_cbranch_vccnz L_RESCALE
L_RESC_RET:
    v_fma_f32 v112, v112, s76, -v236
    v_fma_f32 v113, v113, s76, -v236
    v_fma_f32 v114, v114, s76, -v236
    v_fma_f32 v115, v115, s76, -v236
    v_fma_f32 v116, v116, s76, -v236
    v_fma_f32 v117, v117, s76, -v236
    v_fma_f32 v118, v118, s76, -v236
    v_fma_f32 v119, v119, s76, -v236
    v_exp_f32 v112, v112
    v_exp_f32 v113, v113
    v_exp_f32 v114, v114
    v_exp_f32 v115, v115
    v_exp_f32 v116, v116
    v_exp_f32 v117, v117
    v_exp_f32 v118, v118
    v_exp_f32 v119, v119
    v_cvt_pk_bf16_f32 v144, v112, v113
    v_cvt_pk_bf16_f32 v145, v114, v115
    v_cvt_pk_bf16_f32 v146, v116, v117
    v_cvt_pk_bf16_f32 v147, v118, v119
    v_add_f32 v238, v238, v112
    v_add_f32 v239, v239, v113
    v_add_f32 v240, v240, v114
    v_add_f32 v241, v241, v115
    v_add_f32 v238, v238, v116
    v_add_f32 v239, v239, v117
    v_add_f32 v240, v240, v118
    v_add_f32 v241, v241, v119
    v_mfma_f32_32x32x16_bf16 v[48:63], v[160:163], v[144:147], v[48:63]
    v_fma_f32 v120, v120, s76, -v236
    v_fma_f32 v121, v121, s76, -v236
    v_fma_f32 v122, v122, s76, -v236
    v_fma_f32 v123, v123, s76, -v236
    v_fma_f32 v124, v124, s76, -v236
    v_fma_f32 v125, v125, s76, -v236
    v_fma_f32 v126, v126, s76, -v236
    v_mfma_f32_32x32x16_bf16 v[64:79], v[164:167], v[144:147], v[64:79]
    v_fma_f32 v127, v127, s76, -v236
    v_exp_f32 v120, v120
    v_exp_f32 v121, v121
    v_exp_f32 v122, v122
    v_exp_f32 v123, v123
    v_exp_f32 v124, v124
    v_exp_f32 v125, v125
    v_mfma_f32_32x32x16_bf16 v[80:95], v[168:171], v[144:147], v[80:95]
    v_exp_f32 v126, v126
    v_exp_f32 v127, v127
    v_cvt_pk_bf16_f32 v148, v120, v121
    v_cvt_pk_bf16_f32 v149, v122, v123
    v_cvt_pk_bf16_f32 v150, v124, v125
    v_cvt_pk_bf16_f32 v151, v126, v127
    v_add_f32 v238, v238, v120
    v_mfma_f32_32x32x16_bf16 v[96:111], v[172:175], v[144:147], v[96:111]
    v_add_f32 v239, v239, v121
    v_add_f32 v240, v240, v122
    v_add_f32 v241, v241, v123
    v_add_f32 v238, v238, v124
    v_add_f32 v239, v239, v125
    v_add_f32 v240, v240, v126
    v_add_f32 v241, v241, v127
    v_mfma_f32_32x32x16_bf16 v[48:63], v[176:179], v[148:151], v[48:63]
    v_fma_f32 v128, v128, s76, -v236
    v_fma_f32 v129, v129, s76, -v236
    v_fma_f32 v130, v130, s76, -v236
    v_fma_f32 v131, v131, s76, -v236
    v_fma_f32 v132, v132, s76, -v236
    v_fma_f32 v133, v133, s76, -v236
    v_fma_f32 v134, v134, s76, -v236
    v_mfma_f32_32x32x16_bf16 v[64:79], v[180:183], v[148:151], v[64:79]
    v_fma_f32 v135, v135, s76, -v236
    v_exp_f32 v128, v128
    v_exp_f32 v129, v129
    v_exp_f32 v130, v130
    v_exp_f32 v131, v131
    v_exp_f32 v132, v132
    v_exp_f32 v133, v133
    v_mfma_f32_32x32x16_bf16 v[80:95], v[184:187], v[148:151], v[80:95]
    v_exp_f32 v134, v134
    v_exp_f32 v135, v135
    v_cvt_pk_bf16_f32 v152, v128, v129
    v_cvt_pk_bf16_f32 v153, v130, v131
    v_cvt_pk_bf16_f32 v154, v132, v133
    v_cvt_pk_bf16_f32 v155, v134, v135
    v_add_f32 v238, v238, v128
    v_mfma_f32_32x32x16_bf16 v[96:111], v[188:191], v[148:151], v[96:111]
    v_add_f32 v239, v239, v129
    v_add_f32 v240, v240, v130
    v_add_f32 v241, v241, v131
    v_add_f32 v238, v238, v132
    v_add_f32 v239, v239, v133
    v_add_f32 v240, v240, v134
    v_add_f32 v241, v241, v135
    s_waitcnt lgkmcnt(14)
    v_mfma_f32_32x32x16_bf16 v[48:63], v[192:195], v[152:155], v[48:63]
    v_fma_f32 v136, v136, s76, -v236
    v_fma_f32 v137, v137, s76, -v236
    v_fma_f32 v138, v138, s76, -v236
    v_fma_f32 v139, v139, s76, -v236
    v_fma_f32 v140, v140, s76, -v236
    v_fma_f32 v141, v141, s76, -v236
    v_fma_f32 v142, v142, s76, -v236
    s_waitcnt lgkmcnt(12)
    v_mfma_f32_32x32x16_bf16 v[64:79], v[196:199], v[152:155], v[64:79]
    v_fma_f32 v143, v143, s76, -v236
    v_exp_f32 v136, v136
    v_exp_f32 v137, v137
    v_exp_f32 v138, v138
    v_exp_f32 v139, v139
    v_exp_f32 v140, v140
    v_exp_f32 v141, v141
    s_waitcnt lgkmcnt(10)
    v_mfma_f32_32x32x16_bf16 v[80:95], v[200:203], v[152:155], v[80:95]
    v_exp_f32 v142, v142
    v_exp_f32 v143, v143
    v_cvt_pk_bf16_f32 v156, v136, v137
    v_cvt_pk_bf16_f32 v157, v138, v139
    v_cvt_pk_bf16_f32 v158, v140, v141
    v_cvt_pk_bf16_f32 v159, v142, v143
    v_add_f32 v238, v238, v136
    s_waitcnt lgkmcnt(8)
    v_mfma_f32_32x32x16_bf16 v[96:111], v[204:207], v[152:155], v[96:111]
    v_add_f32 v239, v239, v137
    v_add_f32 v240, v240, v138
    v_add_f32 v241, v241, v139
    v_add_f32 v238, v238, v140
    v_add_f32 v239, v239, v141
    v_add_f32 v240, v240, v142
    v_add_f32 v241, v241, v143
    s_add_u32 s79, s79, 1
    s_cmp_eq_u32 s79, 3
    s_cselect_b32 s14, 0xffff8000, s43
    s_cselect_b32 s79, 0, s79
    v_add_u32 v224, s14, v224
    v_add_u32 v225, s14, v225
    v_add_u32 v226, s14, v226
    v_add_u32 v227, s14, v227
    v_add_u32 v228, s14, v228
    v_add_u32 v229, s14, v229
    v_add_u32 v230, s14, v230
    v_add_u32 v231, s14, v231
    s_waitcnt lgkmcnt(0)
    v_mfma_f32_32x32x16_bf16 v[48:63], v[208:211], v[156:159], v[48:63]
    s_barrier
    ds_read_b128 v[160:163], v224
    ds_read_b128 v[164:167], v225
    ds_read_b128 v[168:171], v226
    ds_read_b128 v[172:175], v227
    ds_read_b128 v[176:179], v228
    ds_read_b128 v[180:183], v229
    ds_read_b128 v[184:187], v230
    ds_read_b128 v[188:191], v231
    v_mfma_f32_32x32x16_bf16 v[64:79], v[212:215], v[156:159], v[64:79]
    v_mfma_f32_32x32x16_bf16 v[80:95], v[216:219], v[156:159], v[80:95]
    v_mfma_f32_32x32x16_bf16 v[96:111], v[220:223], v[156:159], v[96:111]
    v_add_u32 v232, s14, v232
    v_add_u32 v233, s14, v233
    v_add_u32 v234, s14, v234
    v_add_u32 v235, s14, v235
    s_add_u32 s78, s78, 1
    s_cmp_lt_u32 s78, 16
    s_cbranch_scc1 L_TILE
    s_waitcnt lgkmcnt(0)
L_AFTER_TILES:
    s_nop 15
    v_add_f32 v238, v238, v239
    v_add_f32 v240, v240, v241
    v_add_f32 v238, v238, v240
    v_mov_b32 v239, v238
    s_nop 1
    v_permlane32_swap_b32 v238, v239
    s_nop 0
    v_add_f32 v238, v238, v239
    v_rcp_f32 v240, v238
    v_mov_b32 v237, v238
    s_nop 0
    v_pk_mul_f32 v[48:49], v[48:49], v[240:241] op_sel_hi:[1,0]
    v_pk_mul_f32 v[50:51], v[50:51], v[240:241] op_sel_hi:[1,0]
    v_pk_mul_f32 v[52:53], v[52:53], v[240:241] op_sel_hi:[1,0]
    v_pk_mul_f32 v[54:55], v[54:55], v[240:241] op_sel_hi:[1,0]
    v_pk_mul_f32 v[56:57], v[56:57], v[240:241] op_sel_hi:[1,0]
    v_pk_mul_f32 v[58:59], v[58:59], v[240:241] op_sel_hi:[1,0]
    v_pk_mul_f32 v[60:61], v[60:61], v[240:241] op_sel_hi:[1,0]
    v_pk_mul_f32 v[62:63], v[62:63], v[240:241] op_sel_hi:[1,0]
    v_pk_mul_f32 v[64:65], v[64:65], v[240:241] op_sel_hi:[1,0]
    v_pk_mul_f32 v[66:67], v[66:67], v[240:241] op_sel_hi:[1,0]
    v_pk_mul_f32 v[68:69], v[68:69], v[240:241] op_sel_hi:[1,0]
    v_pk_mul_f32 v[70:71], v[70:71], v[240:241] op_sel_hi:[1,0]
    v_pk_mul_f32 v[72:73], v[72:73], v[240:241] op_sel_hi:[1,0]
    v_pk_mul_f32 v[74:75], v[74:75], v[240:241] op_sel_hi:[1,0]
    v_pk_mul_f32 v[76:77], v[76:77], v[240:241] op_sel_hi:[1,0]
    v_pk_mul_f32 v[78:79], v[78:79], v[240:241] op_sel_hi:[1,0]
    v_pk_mul_f32 v[80:81], v[80:81], v[240:241] op_sel_hi:[1,0]
    v_pk_mul_f32 v[82:83], v[82:83], v[240:241] op_sel_hi:[1,0]
    v_pk_mul_f32 v[84:85], v[84:85], v[240:241] op_sel_hi:[1,0]
    v_pk_mul_f32 v[86:87], v[86:87], v[240:241] op_sel_hi:[1,0]
    v_pk_mul_f32 v[88:89], v[88:89], v[240:241] op_sel_hi:[1,0]
    v_pk_mul_f32 v[90:91], v[90:91], v[240:241] op_sel_hi:[1,0]
    v_pk_mul_f32 v[92:93], v[92:93], v[240:241] op_sel_hi:[1,0]
    v_pk_mul_f32 v[94:95], v[94:95], v[240:241] op_sel_hi:[1,0]
    v_pk_mul_f32 v[96:97], v[96:97], v[240:241] op_sel_hi:[1,0]
    v_pk_mul_f32 v[98:99], v[98:99], v[240:241] op_sel_hi:[1,0]
    v_pk_mul_f32 v[100:101], v[100:101], v[240:241] op_sel_hi:[1,0]
    v_pk_mul_f32 v[102:103], v[102:103], v[240:241] op_sel_hi:[1,0]
    v_pk_mul_f32 v[104:105], v[104:105], v[240:241] op_sel_hi:[1,0]
    v_pk_mul_f32 v[106:107], v[106:107], v[240:241] op_sel_hi:[1,0]
    v_pk_mul_f32 v[108:109], v[108:109], v[240:241] op_sel_hi:[1,0]
    v_pk_mul_f32 v[110:111], v[110:111], v[240:241] op_sel_hi:[1,0]
    v_cvt_pk_bf16_f32 v112, v48, v49
    v_cvt_pk_bf16_f32 v113, v50, v51
    v_cvt_pk_bf16_f32 v114, v52, v53
    v_cvt_pk_bf16_f32 v115, v54, v55
    v_cvt_pk_bf16_f32 v116, v56, v57
    v_cvt_pk_bf16_f32 v117, v58, v59
    v_cvt_pk_bf16_f32 v118, v60, v61
    v_cvt_pk_bf16_f32 v119, v62, v63
    v_cvt_pk_bf16_f32 v120, v64, v65
    v_cvt_pk_bf16_f32 v121, v66, v67
    v_cvt_pk_bf16_f32 v122, v68, v69
    v_cvt_pk_bf16_f32 v123, v70, v71
    v_cvt_pk_bf16_f32 v124, v72, v73
    v_cvt_pk_bf16_f32 v125, v74, v75
    v_cvt_pk_bf16_f32 v126, v76, v77
    v_cvt_pk_bf16_f32 v127, v78, v79
    v_cvt_pk_bf16_f32 v128, v80, v81
    v_cvt_pk_bf16_f32 v129, v82, v83
    v_cvt_pk_bf16_f32 v130, v84, v85
    v_cvt_pk_bf16_f32 v131, v86, v87
    v_cvt_pk_bf16_f32 v132, v88, v89
    v_cvt_pk_bf16_f32 v133, v90, v91
    v_cvt_pk_bf16_f32 v134, v92, v93
    v_cvt_pk_bf16_f32 v135, v94, v95
    v_cvt_pk_bf16_f32 v136, v96, v97
    v_cvt_pk_bf16_f32 v137, v98, v99
    v_cvt_pk_bf16_f32 v138, v100, v101
    v_cvt_pk_bf16_f32 v139, v102, v103
    v_cvt_pk_bf16_f32 v140, v104, v105
    v_cvt_pk_bf16_f32 v141, v106, v107
    v_cvt_pk_bf16_f32 v142, v108, v109
    v_cvt_pk_bf16_f32 v143, v110, v111
    s_lshl_b32 s14, s2, 2
    s_add_u32 s14, s14, s3
    s_lshl_b32 s15, s14, 13
    s_add_u32 s15, s15, 0x400000
    s_add_u32 s42, s15, 4096
    v_lshlrev_b32 v9, 4, v1
    v_lshlrev_b32 v10, 3, v1
    buffer_store_dwordx4 v[112:115], v9, s[64:67], s15 offen offset:0 sc0 sc1
    buffer_store_dwordx4 v[116:119], v9, s[64:67], s15 offen offset:1024 sc0 sc1
    buffer_store_dwordx4 v[120:123], v9, s[64:67], s15 offen offset:2048 sc0 sc1
    buffer_store_dwordx4 v[124:127], v9, s[64:67], s15 offen offset:3072 sc0 sc1
    buffer_store_dwordx4 v[128:131], v9, s[64:67], s42 offen offset:0 sc0 sc1
    buffer_store_dwordx4 v[132:135], v9, s[64:67], s42 offen offset:1024 sc0 sc1
    buffer_store_dwordx4 v[136:139], v9, s[64:67], s42 offen offset:2048 sc0 sc1
    buffer_store_dwordx4 v[140:143], v9, s[64:67], s42 offen offset:3072 sc0 sc1
    s_lshl_b32 s15, s14, 9
    s_add_u32 s15, s15, 0xc00000
    buffer_store_dwordx2 v[236:237], v10, s[64:67], s15 offen sc0 sc1
    s_waitcnt vmcnt(0)
    s_lshl_b32 s15, s14, 8
    s_add_u32 s15, s15, 0x1820000
    v_mov_b32 v11, s15
    v_mov_b32 v12, s12
    v_mov_b32 v13, s13
    s_mov_b64 exec, 0x1
    global_store_dwordx2 v11, v[12:13], s[40:41] sc0 sc1
    s_mov_b64 exec, -1
    s_xor_b32 s14, s14, 512
    s_lshl_b32 s15, s14, 8
    s_add_u32 s15, s15, 0x1820000
    v_mov_b32 v11, s15
    s_mov_b64 exec, 0x1
    s_mov_b32 s77, 0
POLL_8:
    global_load_dwordx2 v[12:13], v11, s[40:41] sc0 sc1
    s_waitcnt vmcnt(0)
    v_cmp_ne_u64 vcc, s[12:13], v[12:13]
    s_add_u32 s77, s77, 1
    s_nop 1
    s_cbranch_vccz POLLD_9
    s_cmp_lt_u32 s77, 400000
    s_cbranch_scc1 POLL_8
POLLD_9:
    s_mov_b64 exec, -1
    s_lshl_b32 s15, s14, 9
    s_add_u32 s15, s15, 0xc00000
    buffer_load_dwordx2 v[242:243], v10, s[64:67], s15 offen sc0 sc1
    s_lshl_b32 s15, s14, 13
    s_add_u32 s15, s15, 0x400000
    s_add_u32 s42, s15, 4096
    buffer_load_dwordx4 v[160:163], v9, s[64:67], s15 offen offset:0 sc0 sc1
    buffer_load_dwordx4 v[164:167], v9, s[64:67], s15 offen offset:1024 sc0 sc1
    buffer_load_dwordx4 v[168:171], v9, s[64:67], s15 offen offset:2048 sc0 sc1
    buffer_load_dwordx4 v[172:175], v9, s[64:67], s15 offen offset:3072 sc0 sc1
    buffer_load_dwordx4 v[176:179], v9, s[64:67], s42 offen offset:0 sc0 sc1
    buffer_load_dwordx4 v[180:183], v9, s[64:67], s42 offen offset:1024 sc0 sc1
    buffer_load_dwordx4 v[184:187], v9, s[64:67], s42 offen offset:2048 sc0 sc1
    buffer_load_dwordx4 v[188:191], v9, s[64:67], s42 offen offset:3072 sc0 sc1
    s_waitcnt vmcnt(8)
    v_max_f32 v246, v236, v242
    v_sub_f32 v244, v236, v246
    v_sub_f32 v245, v242, v246
    v_exp_f32 v244, v244
    v_exp_f32 v245, v245
    s_nop 0
    v_mul_f32 v244, v244, v237
    v_mul_f32 v245, v245, v243
    v_add_f32 v246, v244, v245
    v_rcp_f32 v246, v246
    s_nop 0
    v_mul_f32 v244, v244, v246
    v_mul_f32 v245, v245, v246
    v_pk_mul_f32 v[48:49], v[48:49], v[244:245] op_sel_hi:[1,0]
    v_pk_mul_f32 v[50:51], v[50:51], v[244:245] op_sel_hi:[1,0]
    v_pk_mul_f32 v[52:53], v[52:53], v[244:245] op_sel_hi:[1,0]
    v_pk_mul_f32 v[54:55], v[54:55], v[244:245] op_sel_hi:[1,0]
    v_pk_mul_f32 v[56:57], v[56:57], v[244:245] op_sel_hi:[1,0]
    v_pk_mul_f32 v[58:59], v[58:59], v[244:245] op_sel_hi:[1,0]
    v_pk_mul_f32 v[60:61], v[60:61], v[244:245] op_sel_hi:[1,0]
    v_pk_mul_f32 v[62:63], v[62:63], v[244:245] op_sel_hi:[1,0]
    v_pk_mul_f32 v[64:65], v[64:65], v[244:245] op_sel_hi:[1,0]
    v_pk_mul_f32 v[66:67], v[66:67], v[244:245] op_sel_hi:[1,0]
    v_pk_mul_f32 v[68:69], v[68:69], v[244:245] op_sel_hi:[1,0]
    v_pk_mul_f32 v[70:71], v[70:71], v[244:245] op_sel_hi:[1,0]
    v_pk_mul_f32 v[72:73], v[72:73], v[244:245] op_sel_hi:[1,0]
    v_pk_mul_f32 v[74:75], v[74:75], v[244:245] op_sel_hi:[1,0]
    v_pk_mul_f32 v[76:77], v[76:77], v[244:245] op_sel_hi:[1,0]
    v_pk_mul_f32 v[78:79], v[78:79], v[244:245] op_sel_hi:[1,0]
    v_pk_mul_f32 v[80:81], v[80:81], v[244:245] op_sel_hi:[1,0]
    v_pk_mul_f32 v[82:83], v[82:83], v[244:245] op_sel_hi:[1,0]
    v_pk_mul_f32 v[84:85], v[84:85], v[244:245] op_sel_hi:[1,0]
    v_pk_mul_f32 v[86:87], v[86:87], v[244:245] op_sel_hi:[1,0]
    v_pk_mul_f32 v[88:89], v[88:89], v[244:245] op_sel_hi:[1,0]
    v_pk_mul_f32 v[90:91], v[90:91], v[244:245] op_sel_hi:[1,0]
    v_pk_mul_f32 v[92:93], v[92:93], v[244:245] op_sel_hi:[1,0]
    v_pk_mul_f32 v[94:95], v[94:95], v[244:245] op_sel_hi:[1,0]
    v_pk_mul_f32 v[96:97], v[96:97], v[244:245] op_sel_hi:[1,0]
    v_pk_mul_f32 v[98:99], v[98:99], v[244:245] op_sel_hi:[1,0]
    v_pk_mul_f32 v[100:101], v[100:101], v[244:245] op_sel_hi:[1,0]
    v_pk_mul_f32 v[102:103], v[102:103], v[244:245] op_sel_hi:[1,0]
    v_pk_mul_f32 v[104:105], v[104:105], v[244:245] op_sel_hi:[1,0]
    v_pk_mul_f32 v[106:107], v[106:107], v[244:245] op_sel_hi:[1,0]
    v_pk_mul_f32 v[108:109], v[108:109], v[244:245] op_sel_hi:[1,0]
    v_pk_mul_f32 v[110:111], v[110:111], v[244:245] op_sel_hi:[1,0]
    v_lshlrev_b32 v12, 4, v1
    s_lshl_b32 s14, s3, 13
    s_add_u32 s14, s14, 16384
    v_add_u32 v12, s14, v12
    s_waitcnt vmcnt(7)
    v_lshlrev_b32 v247, 16, v160
    v_and_b32 v248, 0xffff0000, v160
    v_fmac_f32 v48, v247, v245
    v_fmac_f32 v49, v248, v245
    v_cvt_pk_bf16_f32 v112, v48, v49
    v_lshlrev_b32 v247, 16, v161
    v_and_b32 v248, 0xffff0000, v161
    v_fmac_f32 v50, v247, v245
    v_fmac_f32 v51, v248, v245
    v_cvt_pk_bf16_f32 v113, v50, v51
    v_lshlrev_b32 v247, 16, v162
    v_and_b32 v248, 0xffff0000, v162
    v_fmac_f32 v52, v247, v245
    v_fmac_f32 v53, v248, v245
    v_cvt_pk_bf16_f32 v114, v52, v53
    v_lshlrev_b32 v247, 16, v163
    v_and_b32 v248, 0xffff0000, v163
    v_fmac_f32 v54, v247, v245
    v_fmac_f32 v55, v248, v245
    v_cvt_pk_bf16_f32 v115, v54, v55
    s_nop 1
    v_permlane32_swap_b32 v112, v114
    v_permlane32_swap_b32 v113, v115
    ds_write_b128 v12, v[112:115] offset:0
    s_waitcnt vmcnt(6)
    v_lshlrev_b32 v247, 16, v164
    v_and_b32 v248, 0xffff0000, v164
    v_fmac_f32 v56, v247, v245
    v_fmac_f32 v57, v248, v245
    v_cvt_pk_bf16_f32 v116, v56, v57
    v_lshlrev_b32 v247, 16, v165
    v_and_b32 v248, 0xffff0000, v165
    v_fmac_f32 v58, v247, v245
    v_fmac_f32 v59, v248, v245
    v_cvt_pk_bf16_f32 v117, v58, v59
    v_lshlrev_b32 v247, 16, v166
    v_and_b32 v248, 0xffff0000, v166
    v_fmac_f32 v60, v247, v245
    v_fmac_f32 v61, v248, v245
    v_cvt_pk_bf16_f32 v118, v60, v61
    v_lshlrev_b32 v247, 16, v167
    v_and_b32 v248, 0xffff0000, v167
    v_fmac_f32 v62, v247, v245
    v_fmac_f32 v63, v248, v245
    v_cvt_pk_bf16_f32 v119, v62, v63
    s_nop 1
    v_permlane32_swap_b32 v116, v118
    v_permlane32_swap_b32 v117, v119
    ds_write_b128 v12, v[116:119] offset:1024
    s_waitcnt vmcnt(5)
    v_lshlrev_b32 v247, 16, v168
    v_and_b32 v248, 0xffff0000, v168
    v_fmac_f32 v64, v247, v245
    v_fmac_f32 v65, v248, v245
    v_cvt_pk_bf16_f32 v120, v64, v65
    v_lshlrev_b32 v247, 16, v169
    v_and_b32 v248, 0xffff0000, v169
    v_fmac_f32 v66, v247, v245
    v_fmac_f32 v67, v248, v245
    v_cvt_pk_bf16_f32 v121, v66, v67
    v_lshlrev_b32 v247, 16, v170
    v_and_b32 v248, 0xffff0000, v170
    v_fmac_f32 v68, v247, v245
    v_fmac_f32 v69, v248, v245
    v_cvt_pk_bf16_f32 v122, v68, v69
    v_lshlrev_b32 v247, 16, v171
    v_and_b32 v248, 0xffff0000, v171
    v_fmac_f32 v70, v247, v245
    v_fmac_f32 v71, v248, v245
    v_cvt_pk_bf16_f32 v123, v70, v71
    s_nop 1
    v_permlane32_swap_b32 v120, v122
    v_permlane32_swap_b32 v121, v123
    ds_write_b128 v12, v[120:123] offset:2048
    s_waitcnt vmcnt(4)
    v_lshlrev_b32 v247, 16, v172
    v_and_b32 v248, 0xffff0000, v172
    v_fmac_f32 v72, v247, v245
    v_fmac_f32 v73, v248, v245
    v_cvt_pk_bf16_f32 v124, v72, v73
    v_lshlrev_b32 v247, 16, v173
    v_and_b32 v248, 0xffff0000, v173
    v_fmac_f32 v74, v247, v245
    v_fmac_f32 v75, v248, v245
    v_cvt_pk_bf16_f32 v125, v74, v75
    v_lshlrev_b32 v247, 16, v174
    v_and_b32 v248, 0xffff0000, v174
    v_fmac_f32 v76, v247, v245
    v_fmac_f32 v77, v248, v245
    v_cvt_pk_bf16_f32 v126, v76, v77
    v_lshlrev_b32 v247, 16, v175
    v_and_b32 v248, 0xffff0000, v175
    v_fmac_f32 v78, v247, v245
    v_fmac_f32 v79, v248, v245
    v_cvt_pk_bf16_f32 v127, v78, v79
    s_nop 1
    v_permlane32_swap_b32 v124, v126
    v_permlane32_swap_b32 v125, v127
    ds_write_b128 v12, v[124:127] offset:3072
    s_waitcnt vmcnt(3)
    v_lshlrev_b32 v247, 16, v176
    v_and_b32 v248, 0xffff0000, v176
    v_fmac_f32 v80, v247, v245
    v_fmac_f32 v81, v248, v245
    v_cvt_pk_bf16_f32 v128, v80, v81
    v_lshlrev_b32 v247, 16, v177
    v_and_b32 v248, 0xffff0000, v177
    v_fmac_f32 v82, v247, v245
    v_fmac_f32 v83, v248, v245
    v_cvt_pk_bf16_f32 v129, v82, v83
    v_lshlrev_b32 v247, 16, v178
    v_and_b32 v248, 0xffff0000, v178
    v_fmac_f32 v84, v247, v245
    v_fmac_f32 v85, v248, v245
    v_cvt_pk_bf16_f32 v130, v84, v85
    v_lshlrev_b32 v247, 16, v179
    v_and_b32 v248, 0xffff0000, v179
    v_fmac_f32 v86, v247, v245
    v_fmac_f32 v87, v248, v245
    v_cvt_pk_bf16_f32 v131, v86, v87
    s_nop 1
    v_permlane32_swap_b32 v128, v130
    v_permlane32_swap_b32 v129, v131
    ds_write_b128 v12, v[128:131] offset:4096
    s_waitcnt vmcnt(2)
    v_lshlrev_b32 v247, 16, v180
    v_and_b32 v248, 0xffff0000, v180
    v_fmac_f32 v88, v247, v245
    v_fmac_f32 v89, v248, v245
    v_cvt_pk_bf16_f32 v132, v88, v89
    v_lshlrev_b32 v247, 16, v181
    v_and_b32 v248, 0xffff0000, v181
    v_fmac_f32 v90, v247, v245
    v_fmac_f32 v91, v248, v245
    v_cvt_pk_bf16_f32 v133, v90, v91
    v_lshlrev_b32 v247, 16, v182
    v_and_b32 v248, 0xffff0000, v182
    v_fmac_f32 v92, v247, v245
    v_fmac_f32 v93, v248, v245
    v_cvt_pk_bf16_f32 v134, v92, v93
    v_lshlrev_b32 v247, 16, v183
    v_and_b32 v248, 0xffff0000, v183
    v_fmac_f32 v94, v247, v245
    v_fmac_f32 v95, v248, v245
    v_cvt_pk_bf16_f32 v135, v94, v95
    s_nop 1
    v_permlane32_swap_b32 v132, v134
    v_permlane32_swap_b32 v133, v135
    ds_write_b128 v12, v[132:135] offset:5120
    s_waitcnt vmcnt(1)
    v_lshlrev_b32 v247, 16, v184
    v_and_b32 v248, 0xffff0000, v184
    v_fmac_f32 v96, v247, v245
    v_fmac_f32 v97, v248, v245
    v_cvt_pk_bf16_f32 v136, v96, v97
    v_lshlrev_b32 v247, 16, v185
    v_and_b32 v248, 0xffff0000, v185
    v_fmac_f32 v98, v247, v245
    v_fmac_f32 v99, v248, v245
    v_cvt_pk_bf16_f32 v137, v98, v99
    v_lshlrev_b32 v247, 16, v186
    v_and_b32 v248, 0xffff0000, v186
    v_fmac_f32 v100, v247, v245
    v_fmac_f32 v101, v248, v245
    v_cvt_pk_bf16_f32 v138, v100, v101
    v_lshlrev_b32 v247, 16, v187
    v_and_b32 v248, 0xffff0000, v187
    v_fmac_f32 v102, v247, v245
    v_fmac_f32 v103, v248, v245
    v_cvt_pk_bf16_f32 v139, v102, v103
    s_nop 1
    v_permlane32_swap_b32 v136, v138
    v_permlane32_swap_b32 v137, v139
    ds_write_b128 v12, v[136:139] offset:6144
    s_waitcnt vmcnt(0)
    v_lshlrev_b32 v247, 16, v188
    v_and_b32 v248, 0xffff0000, v188
    v_fmac_f32 v104, v247, v245
    v_fmac_f32 v105, v248, v245
    v_cvt_pk_bf16_f32 v140, v104, v105
    v_lshlrev_b32 v247, 16, v189
    v_and_b32 v248, 0xffff0000, v189
    v_fmac_f32 v106, v247, v245
    v_fmac_f32 v107, v248, v245
    v_cvt_pk_bf16_f32 v141, v106, v107
    v_lshlrev_b32 v247, 16, v190
    v_and_b32 v248, 0xffff0000, v190
    v_fmac_f32 v108, v247, v245
    v_fmac_f32 v109, v248, v245
    v_cvt_pk_bf16_f32 v142, v108, v109
    v_lshlrev_b32 v247, 16, v191
    v_and_b32 v248, 0xffff0000, v191
    v_fmac_f32 v110, v247, v245
    v_fmac_f32 v111, v248, v245
    v_cvt_pk_bf16_f32 v143, v110, v111
    s_nop 1
    v_permlane32_swap_b32 v140, v142
    v_permlane32_swap_b32 v141, v143
    ds_write_b128 v12, v[140:143] offset:7168
    s_waitcnt lgkmcnt(0)
    s_barrier
    s_lshl_b32 s14, s4, 3
    s_add_u32 s14, s14, s8
    s_lshl_b32 s14, s14, 1
    s_add_u32 s14, s14, s9
    s_lshl_b32 s14, s14, 3
    s_add_u32 s14, s14, s7
    s_lshl_b32 s15, s14, 11
    s_add_u32 s15, s15, 0x1880000
    v_lshlrev_b32 v11, 8, v1
    v_add_u32 v11, s15, v11
    s_mov_b64 exec, 0xff
    s_mov_b32 s77, 0
POLL_10:
    global_load_dwordx2 v[12:13], v11, s[40:41] sc0 sc1
    s_waitcnt vmcnt(0)
    v_cmp_ne_u64 vcc, s[12:13], v[12:13]
    s_add_u32 s77, s77, 1
    s_nop 1
    s_cbranch_vccz POLLD_11
    s_cmp_lt_u32 s77, 400000
    s_cbranch_scc1 POLL_10
POLLD_11:
    s_mov_b64 exec, -1
    s_lshl_b32 s15, s14, 14
    s_add_u32 s15, s15, 0x1000000
    s_lshr_b32 s14, s3, 1
    s_lshl_b32 s14, s14, 10
    s_add_u32 s15, s15, s14
    s_and_b32 s14, s3, 1
    s_lshl_b32 s14, s14, 3
    s_add_u32 s15, s15, s14
    s_add_u32 s14, s15, 0
    buffer_load_dwordx2 v[16:17], v9, s[64:67], s14 offen sc0 sc1
    s_add_u32 s14, s15, 2048
    buffer_load_dwordx2 v[18:19], v9, s[64:67], s14 offen sc0 sc1
    s_add_u32 s14, s15, 4096
    buffer_load_dwordx2 v[20:21], v9, s[64:67], s14 offen sc0 sc1
    s_add_u32 s14, s15, 6144
    buffer_load_dwordx2 v[22:23], v9, s[64:67], s14 offen sc0 sc1
    s_add_u32 s14, s15, 8192
    buffer_load_dwordx2 v[24:25], v9, s[64:67], s14 offen sc0 sc1
    s_add_u32 s14, s15, 10240
    buffer_load_dwordx2 v[26:27], v9, s[64:67], s14 offen sc0 sc1
    s_add_u32 s14, s15, 12288
    buffer_load_dwordx2 v[28:29], v9, s[64:67], s14 offen sc0 sc1
    s_add_u32 s14, s15, 14336
    buffer_load_dwordx2 v[30:31], v9, s[64:67], s14 offen sc0 sc1
    s_waitcnt vmcnt(7)
    v_lshlrev_b32 v40, 16, v16
    v_and_b32 v41, 0xffff0000, v16
    v_lshlrev_b32 v42, 16, v17
    v_and_b32 v43, 0xffff0000, v17
    s_waitcnt vmcnt(6)
    v_lshlrev_b32 v44, 16, v18
    v_and_b32 v45, 0xffff0000, v18
    v_add_f32 v40, v40, v44
    v_add_f32 v41, v41, v45
    v_lshlrev_b32 v44, 16, v19
    v_and_b32 v45, 0xffff0000, v19
    v_add_f32 v42, v42, v44
    v_add_f32 v43, v43, v45
    s_waitcnt vmcnt(5)
    v_lshlrev_b32 v44, 16, v20
    v_and_b32 v45, 0xffff0000, v20
    v_add_f32 v40, v40, v44
    v_add_f32 v41, v41, v45
    v_lshlrev_b32 v44, 16, v21
    v_and_b32 v45, 0xffff0000, v21
    v_add_f32 v42, v42, v44
    v_add_f32 v43, v43, v45
    s_waitcnt vmcnt(4)
    v_lshlrev_b32 v44, 16, v22
    v_and_b32 v45, 0xffff0000, v22
    v_add_f32 v40, v40, v44
    v_add_f32 v41, v41, v45
    v_lshlrev_b32 v44, 16, v23
    v_and_b32 v45, 0xffff0000, v23
    v_add_f32 v42, v42, v44
    v_add_f32 v43, v43, v45
    s_waitcnt vmcnt(3)
    v_lshlrev_b32 v44, 16, v24
    v_and_b32 v45, 0xffff0000, v24
    v_add_f32 v40, v40, v44
    v_add_f32 v41, v41, v45
    v_lshlrev_b32 v44, 16, v25
    v_and_b32 v45, 0xffff0000, v25
    v_add_f32 v42, v42, v44
    v_add_f32 v43, v43, v45
    s_waitcnt vmcnt(2)
    v_lshlrev_b32 v44, 16, v26
    v_and_b32 v45, 0xffff0000, v26
    v_add_f32 v40, v40, v44
    v_add_f32 v41, v41, v45
    v_lshlrev_b32 v44, 16, v27
    v_and_b32 v45, 0xffff0000, v27
    v_add_f32 v42, v42, v44
    v_add_f32 v43, v43, v45
    s_waitcnt vmcnt(1)
    v_lshlrev_b32 v44, 16, v28
    v_and_b32 v45, 0xffff0000, v28
    v_add_f32 v40, v40, v44
    v_add_f32 v41, v41, v45
    v_lshlrev_b32 v44, 16, v29
    v_and_b32 v45, 0xffff0000, v29
    v_add_f32 v42, v42, v44
    v_add_f32 v43, v43, v45
    s_waitcnt vmcnt(0)
    v_lshlrev_b32 v44, 16, v30
    v_and_b32 v45, 0xffff0000, v30
    v_add_f32 v40, v40, v44
    v_add_f32 v41, v41, v45
    v_lshlrev_b32 v44, 16, v31
    v_and_b32 v45, 0xffff0000, v31
    v_add_f32 v42, v42, v44
    v_add_f32 v43, v43, v45
    v_cvt_pk_bf16_f32 v46, v40, v41
    v_cvt_pk_bf16_f32 v47, v42, v43
    s_lshl_b32 s14, s8, 16
    s_lshl_b32 s15, s4, 10
    s_add_u32 s14, s14, s15
    s_lshl_b32 s15, s9, 9
    s_add_u32 s14, s14, s15
    s_lshl_b32 s15, s7, 6
    s_add_u32 s14, s14, s15
    s_lshl_b32 s15, s3, 4
    s_add_u32 s14, s14, s15
    v_lshlrev_b32 v11, 11, v5
    v_lshl_add_u32 v11, v4, 3, v11
    buffer_store_dwordx2 v[46:47], v11, s[68:71], s14 offen
    s_branch L_FIN
L_RESCALE:
    s_nop 15
    v_max_f32 v243, v236, v242
    v_sub_f32 v244, v236, v243
    v_exp_f32 v244, v244
    v_mov_b32 v236, v243
    v_add_f32 v237, 0x41000000, v243
    v_mul_f32 v48, v48, v244
    v_mul_f32 v49, v49, v244
    v_mul_f32 v50, v50, v244
    v_mul_f32 v51, v51, v244
    v_mul_f32 v52, v52, v244
    v_mul_f32 v53, v53, v244
    v_mul_f32 v54, v54, v244
    v_mul_f32 v55, v55, v244
    v_mul_f32 v56, v56, v244
    v_mul_f32 v57, v57, v244
    v_mul_f32 v58, v58, v244
    v_mul_f32 v59, v59, v244
    v_mul_f32 v60, v60, v244
    v_mul_f32 v61, v61, v244
    v_mul_f32 v62, v62, v244
    v_mul_f32 v63, v63, v244
    v_mul_f32 v64, v64, v244
    v_mul_f32 v65, v65, v244
    v_mul_f32 v66, v66, v244
    v_mul_f32 v67, v67, v244
    v_mul_f32 v68, v68, v244
    v_mul_f32 v69, v69, v244
    v_mul_f32 v70, v70, v244
    v_mul_f32 v71, v71, v244
    v_mul_f32 v72, v72, v244
    v_mul_f32 v73, v73, v244
    v_mul_f32 v74, v74, v244
    v_mul_f32 v75, v75, v244
    v_mul_f32 v76, v76, v244
    v_mul_f32 v77, v77, v244
    v_mul_f32 v78, v78, v244
    v_mul_f32 v79, v79, v244
    v_mul_f32 v80, v80, v244
    v_mul_f32 v81, v81, v244
    v_mul_f32 v82, v82, v244
    v_mul_f32 v83, v83, v244
    v_mul_f32 v84, v84, v244
    v_mul_f32 v85, v85, v244
    v_mul_f32 v86, v86, v244
    v_mul_f32 v87, v87, v244
    v_mul_f32 v88, v88, v244
    v_mul_f32 v89, v89, v244
    v_mul_f32 v90, v90, v244
    v_mul_f32 v91, v91, v244
    v_mul_f32 v92, v92, v244
    v_mul_f32 v93, v93, v244
    v_mul_f32 v94, v94, v244
    v_mul_f32 v95, v95, v244
    v_mul_f32 v96, v96, v244
    v_mul_f32 v97, v97, v244
    v_mul_f32 v98, v98, v244
    v_mul_f32 v99, v99, v244
    v_mul_f32 v100, v100, v244
    v_mul_f32 v101, v101, v244
    v_mul_f32 v102, v102, v244
    v_mul_f32 v103, v103, v244
    v_mul_f32 v104, v104, v244
    v_mul_f32 v105, v105, v244
    v_mul_f32 v106, v106, v244
    v_mul_f32 v107, v107, v244
    v_mul_f32 v108, v108, v244
    v_mul_f32 v109, v109, v244
    v_mul_f32 v110, v110, v244
    v_mul_f32 v111, v111, v244
    v_mul_f32 v238, v238, v244
    v_mul_f32 v239, v239, v244
    v_mul_f32 v240, v240, v244
    v_mul_f32 v241, v241, v244
    s_branch L_RESC_RET
L_HELPER:
    s_sub_u32 s78, s3, 4
    v_mov_b32 v214, v19
    v_xor_b32 v9, v2, v3
    v_lshlrev_b32 v10, 8, v3
    v_xor_b32 v11, 0, v9
    v_lshl_add_u32 v208, v11, 4, v10
    v_xor_b32 v11, 4, v9
    v_lshl_add_u32 v209, v11, 4, v10
    v_xor_b32 v11, 8, v9
    v_lshl_add_u32 v210, v11, 4, v10
    v_xor_b32 v11, 12, v9
    v_lshl_add_u32 v211, v11, 4, v10
    v_lshlrev_b32 v9, 2, v3
    v_xor_b32 v9, v9, v2
    v_lshl_add_u32 v212, v9, 4, v10
    v_and_b32 v9, 7, v1
    v_lshlrev_b32 v10, 2, v7
    v_xor_b32 v9, v9, v10
    v_lshrrev_b32 v10, 3, v1
    v_lshlrev_b32 v10, 10, v10
    v_lshl_add_u32 v9, v9, 4, v10
    s_lshl_b32 s14, s78, 7
    v_add_u32 v213, s14, v9
    v_lshl_add_u32 v9, v4, 3, v6
    v_lshlrev_b32 v9, 7, v9
    v_lshl_add_u32 v9, v7, 5, v9
    v_lshl_add_u32 v9, v8, 3, v9
    s_lshl_b32 s14, s78, 14
    s_add_u32 s14, s14, 98304
    v_add_u32 v9, s14, v9
    v_lshrrev_b32 v10, 1, v6
    v_lshl_add_u32 v12, v10, 6, v9
    v_xor_b32 v10, 1, v10
    v_lshl_add_u32 v13, v10, 6, v9
    v_lshlrev_b32 v14, 4, v1
    v_add_u32 v14, 16384, v14
    s_lshl_b32 s79, s78, 12
    s_mov_b32 s42, s14
    s_add_u32 s14, s79, 0
    s_mov_b32 m0, s14
    s_add_u32 s15, s79, 0
    buffer_load_dwordx4 v208, s[52:55], s15 offen offset:0 nt lds
    buffer_load_dwordx4 v209, s[52:55], s15 offen offset:1024 nt lds
    buffer_load_dwordx4 v210, s[52:55], s15 offen offset:2048 nt lds
    buffer_load_dwordx4 v211, s[52:55], s15 offen offset:3072 nt lds
    s_add_u32 s14, s79, 49152
    s_mov_b32 m0, s14
    s_nop 0
    buffer_load_dwordx4 v212, s[56:59], s15 offen offset:0 nt lds
    buffer_load_dwordx4 v212, s[56:59], s15 offen offset:1024 nt lds
    buffer_load_dwordx4 v212, s[56:59], s15 offen offset:2048 nt lds
    buffer_load_dwordx4 v212, s[56:59], s15 offen offset:3072 nt lds
    s_add_u32 s14, s79, 16384
    s_mov_b32 m0, s14
    s_add_u32 s15, s79, 16384
    buffer_load_dwordx4 v208, s[52:55], s15 offen offset:0 nt lds
    buffer_load_dwordx4 v209, s[52:55], s15 offen offset:1024 nt lds
    buffer_load_dwordx4 v210, s[52:55], s15 offen offset:2048 nt lds
    buffer_load_dwordx4 v211, s[52:55], s15 offen offset:3072 nt lds
    s_add_u32 s14, s79, 65536
    s_mov_b32 m0, s14
    s_nop 0
    buffer_load_dwordx4 v212, s[56:59], s15 offen offset:0 nt lds
    buffer_load_dwordx4 v212, s[56:59], s15 offen offset:1024 nt lds
    buffer_load_dwordx4 v212, s[56:59], s15 offen offset:2048 nt lds
    buffer_load_dwordx4 v212, s[56:59], s15 offen offset:3072 nt lds
    s_waitcnt vmcnt(8)
    s_barrier
    s_add_u32 s14, s79, 32768
    s_mov_b32 m0, s14
    s_add_u32 s15, s79, 32768
    buffer_load_dwordx4 v208, s[52:55], s15 offen offset:0 nt lds
    buffer_load_dwordx4 v209, s[52:55], s15 offen offset:1024 nt lds
    buffer_load_dwordx4 v210, s[52:55], s15 offen offset:2048 nt lds
    buffer_load_dwordx4 v211, s[52:55], s15 offen offset:3072 nt lds
    s_add_u32 s14, s79, 81920
    s_mov_b32 m0, s14
    s_nop 0
    buffer_load_dwordx4 v212, s[56:59], s15 offen offset:0 nt lds
    buffer_load_dwordx4 v212, s[56:59], s15 offen offset:1024 nt lds
    buffer_load_dwordx4 v212, s[56:59], s15 offen offset:2048 nt lds
    buffer_load_dwordx4 v212, s[56:59], s15 offen offset:3072 nt lds
    s_waitcnt vmcnt(8)
    s_barrier
    s_add_u32 s14, s79, 0
    s_mov_b32 m0, s14
    s_add_u32 s15, s79, 49152
    buffer_load_dwordx4 v208, s[52:55], s15 offen offset:0 nt lds
    buffer_load_dwordx4 v209, s[52:55], s15 offen offset:1024 nt lds
    buffer_load_dwordx4 v210, s[52:55], s15 offen offset:2048 nt lds
    buffer_load_dwordx4 v211, s[52:55], s15 offen offset:3072 nt lds
    s_add_u32 s14, s79, 49152
    s_mov_b32 m0, s14
    s_nop 0
    buffer_load_dwordx4 v212, s[56:59], s15 offen offset:0 nt lds
    buffer_load_dwordx4 v212, s[56:59], s15 offen offset:1024 nt lds
    buffer_load_dwordx4 v212, s[56:59], s15 offen offset:2048 nt lds
    buffer_load_dwordx4 v212, s[56:59], s15 offen offset:3072 nt lds
    s_add_u32 s14, s42, 0
    s_mov_b32 m0, s14
    s_mov_b32 s15, 0
    buffer_load_dwordx4 v213, s[60:63], s15 offen offset:0 nt lds
    s_mov_b32 s15, 7168
    buffer_load_dwordx4 v213, s[60:63], s15 offen offset:1024 nt lds
    s_mov_b32 s15, 14336
    buffer_load_dwordx4 v213, s[60:63], s15 offen offset:2048 nt lds
    s_mov_b32 s15, 21504
    buffer_load_dwordx4 v213, s[60:63], s15 offen offset:3072 nt lds
    s_add_u32 s14, s42, 4096
    s_mov_b32 m0, s14
    s_mov_b32 s15, 32768
    buffer_load_dwordx4 v213, s[60:63], s15 offen offset:0 nt lds
    s_mov_b32 s15, 39936
    buffer_load_dwordx4 v213, s[60:63], s15 offen offset:1024 nt lds
    s_mov_b32 s15, 47104
    buffer_load_dwordx4 v213, s[60:63], s15 offen offset:2048 nt lds
    s_mov_b32 s15, 54272
    buffer_load_dwordx4 v213, s[60:63], s15 offen offset:3072 nt lds
    s_waitcnt vmcnt(16)
    s_barrier
    s_add_u32 s14, s79, 16384
    s_mov_b32 m0, s14
    s_add_u32 s15, s79, 65536
    buffer_load_dwordx4 v208, s[52:55], s15 offen offset:0 nt lds
    buffer_load_dwordx4 v209, s[52:55], s15 offen offset:1024 nt lds
    buffer_load_dwordx4 v210, s[52:55], s15 offen offset:2048 nt lds
    buffer_load_dwordx4 v211, s[52:55], s15 offen offset:3072 nt lds
    s_add_u32 s14, s79, 65536
    s_mov_b32 m0, s14
    s_nop 0
    buffer_load_dwordx4 v212, s[56:59], s15 offen offset:0 nt lds
    buffer_load_dwordx4 v212, s[56:59], s15 offen offset:1024 nt lds
    buffer_load_dwordx4 v212, s[56:59], s15 offen offset:2048 nt lds
    buffer_load_dwordx4 v212, s[56:59], s15 offen offset:3072 nt lds
    s_add_u32 s14, s42, 8192
    s_mov_b32 m0, s14
    s_mov_b32 s15, 65536
    buffer_load_dwordx4 v213, s[60:63], s15 offen offset:0 nt lds
    s_mov_b32 s15, 72704
    buffer_load_dwordx4 v213, s[60:63], s15 offen offset:1024 nt lds
    s_mov_b32 s15, 79872
    buffer_load_dwordx4 v213, s[60:63], s15 offen offset:2048 nt lds
    s_mov_b32 s15, 87040
    buffer_load_dwordx4 v213, s[60:63], s15 offen offset:3072 nt lds
    s_add_u32 s14, s42, 12288
    s_mov_b32 m0, s14
    s_mov_b32 s15, 98304
    buffer_load_dwordx4 v213, s[60:63], s15 offen offset:0 nt lds
    s_mov_b32 s15, 105472
    buffer_load_dwordx4 v213, s[60:63], s15 offen offset:1024 nt lds
    s_mov_b32 s15, 112640
    buffer_load_dwordx4 v213, s[60:63], s15 offen offset:2048 nt lds
    s_mov_b32 s15, 119808
    buffer_load_dwordx4 v213, s[60:63], s15 offen offset:3072 nt lds
    s_waitcnt vmcnt(24)
    s_barrier
    s_add_u32 s14, s79, 32768
    s_mov_b32 m0, s14
    s_add_u32 s15, s79, 81920
    buffer_load_dwordx4 v208, s[52:55], s15 offen offset:0 nt lds
    buffer_load_dwordx4 v209, s[52:55], s15 offen offset:1024 nt lds
    buffer_load_dwordx4 v210, s[52:55], s15 offen offset:2048 nt lds
    buffer_load_dwordx4 v211, s[52:55], s15 offen offset:3072 nt lds
    s_add_u32 s14, s79, 81920
    s_mov_b32 m0, s14
    s_nop 0
    buffer_load_dwordx4 v212, s[56:59], s15 offen offset:0 nt lds
    buffer_load_dwordx4 v212, s[56:59], s15 offen offset:1024 nt lds
    buffer_load_dwordx4 v212, s[56:59], s15 offen offset:2048 nt lds
    buffer_load_dwordx4 v212, s[56:59], s15 offen offset:3072 nt lds
    s_waitcnt vmcnt(24)
    ds_read_b64_tr_b16 v[16:17], v12 offset:0
    ds_read_b64_tr_b16 v[18:19], v12 offset:512
    ds_read_b64_tr_b16 v[20:21], v13 offset:0
    ds_read_b64_tr_b16 v[22:23], v13 offset:512
    ds_read_b64_tr_b16 v[24:25], v12 offset:2048
    ds_read_b64_tr_b16 v[26:27], v12 offset:2560
    ds_read_b64_tr_b16 v[28:29], v13 offset:2048
    ds_read_b64_tr_b16 v[30:31], v13 offset:2560
    ds_read_b64_tr_b16 v[32:33], v12 offset:4096
    ds_read_b64_tr_b16 v[34:35], v12 offset:4608
    ds_read_b64_tr_b16 v[36:37], v13 offset:4096
    ds_read_b64_tr_b16 v[38:39], v13 offset:4608
    ds_read_b64_tr_b16 v[40:41], v12 offset:6144
    ds_read_b64_tr_b16 v[42:43], v12 offset:6656
    ds_read_b64_tr_b16 v[44:45], v13 offset:6144
    s_waitcnt lgkmcnt(14)
    ds_read_b64_tr_b16 v[46:47], v13 offset:6656
    s_waitcnt lgkmcnt(0)
    s_waitcnt vmcnt(16)
    s_barrier
    s_add_u32 s14, s79, 0
    s_mov_b32 m0, s14
    s_add_u32 s15, s79, 98304
    buffer_load_dwordx4 v208, s[52:55], s15 offen offset:0 nt lds
    buffer_load_dwordx4 v209, s[52:55], s15 offen offset:1024 nt lds
    buffer_load_dwordx4 v210, s[52:55], s15 offen offset:2048 nt lds
    buffer_load_dwordx4 v211, s[52:55], s15 offen offset:3072 nt lds
    s_add_u32 s14, s79, 49152
    s_mov_b32 m0, s14
    s_nop 0
    buffer_load_dwordx4 v212, s[56:59], s15 offen offset:0 nt lds
    buffer_load_dwordx4 v212, s[56:59], s15 offen offset:1024 nt lds
    buffer_load_dwordx4 v212, s[56:59], s15 offen offset:2048 nt lds
    buffer_load_dwordx4 v212, s[56:59], s15 offen offset:3072 nt lds
    s_waitcnt vmcnt(16)
    ds_read_b64_tr_b16 v[48:49], v12 offset:8192
    ds_read_b64_tr_b16 v[50:51], v12 offset:8704
    ds_read_b64_tr_b16 v[52:53], v13 offset:8192
    ds_read_b64_tr_b16 v[54:55], v13 offset:8704
    ds_read_b64_tr_b16 v[56:57], v12 offset:10240
    ds_read_b64_tr_b16 v[58:59], v12 offset:10752
    ds_read_b64_tr_b16 v[60:61], v13 offset:10240
    ds_read_b64_tr_b16 v[62:63], v13 offset:10752
    ds_read_b64_tr_b16 v[64:65], v12 offset:12288
    ds_read_b64_tr_b16 v[66:67], v12 offset:12800
    ds_read_b64_tr_b16 v[68:69], v13 offset:12288
    ds_read_b64_tr_b16 v[70:71], v13 offset:12800
    ds_read_b64_tr_b16 v[72:73], v12 offset:14336
    ds_read_b64_tr_b16 v[74:75], v12 offset:14848
    ds_read_b64_tr_b16 v[76:77], v13 offset:14336
    s_waitcnt lgkmcnt(14)
    ds_read_b64_tr_b16 v[78:79], v13 offset:14848
    s_waitcnt lgkmcnt(0)
    s_add_u32 s14, s42, 0
    s_mov_b32 m0, s14
    s_mov_b32 s15, 131072
    buffer_load_dwordx4 v213, s[60:63], s15 offen offset:0 nt lds
    s_mov_b32 s15, 138240
    buffer_load_dwordx4 v213, s[60:63], s15 offen offset:1024 nt lds
    s_mov_b32 s15, 145408
    buffer_load_dwordx4 v213, s[60:63], s15 offen offset:2048 nt lds
    s_mov_b32 s15, 152576
    buffer_load_dwordx4 v213, s[60:63], s15 offen offset:3072 nt lds
    s_add_u32 s14, s42, 4096
    s_mov_b32 m0, s14
    s_mov_b32 s15, 163840
    buffer_load_dwordx4 v213, s[60:63], s15 offen offset:0 nt lds
    s_mov_b32 s15, 171008
    buffer_load_dwordx4 v213, s[60:63], s15 offen offset:1024 nt lds
    s_mov_b32 s15, 178176
    buffer_load_dwordx4 v213, s[60:63], s15 offen offset:2048 nt lds
    s_mov_b32 s15, 185344
    buffer_load_dwordx4 v213, s[60:63], s15 offen offset:3072 nt lds
    s_waitcnt vmcnt(16)
    s_barrier
    s_add_u32 s14, s79, 16384
    s_mov_b32 m0, s14
    s_add_u32 s15, s79, 114688
    buffer_load_dwordx4 v208, s[52:55], s15 offen offset:0 nt lds
    buffer_load_dwordx4 v209, s[52:55], s15 offen offset:1024 nt lds
    buffer_load_dwordx4 v210, s[52:55], s15 offen offset:2048 nt lds
    buffer_load_dwordx4 v211, s[52:55], s15 offen offset:3072 nt lds
    s_add_u32 s14, s79, 65536
    s_mov_b32 m0, s14
    s_nop 0
    buffer_load_dwordx4 v212, s[56:59], s15 offen offset:0 nt lds
    buffer_load_dwordx4 v212, s[56:59], s15 offen offset:1024 nt lds
    buffer_load_dwordx4 v212, s[56:59], s15 offen offset:2048 nt lds
    buffer_load_dwordx4 v212, s[56:59], s15 offen offset:3072 nt lds
    s_add_u32 s14, s42, 8192
    s_mov_b32 m0, s14
    s_mov_b32 s15, 196608
    buffer_load_dwordx4 v213, s[60:63], s15 offen offset:0 nt lds
    s_mov_b32 s15, 203776
    buffer_load_dwordx4 v213, s[60:63], s15 offen offset:1024 nt lds
    s_mov_b32 s15, 210944
    buffer_load_dwordx4 v213, s[60:63], s15 offen offset:2048 nt lds
    s_mov_b32 s15, 218112
    buffer_load_dwordx4 v213, s[60:63], s15 offen offset:3072 nt lds
    s_add_u32 s14, s42, 12288
    s_mov_b32 m0, s14
    s_mov_b32 s15, 229376
    buffer_load_dwordx4 v213, s[60:63], s15 offen offset:0 nt lds
    s_mov_b32 s15, 236544
    buffer_load_dwordx4 v213, s[60:63], s15 offen offset:1024 nt lds
    s_mov_b32 s15, 243712
    buffer_load_dwordx4 v213, s[60:63], s15 offen offset:2048 nt lds
    s_mov_b32 s15, 250880
    buffer_load_dwordx4 v213, s[60:63], s15 offen offset:3072 nt lds
    s_waitcnt vmcnt(24)
    s_barrier
    s_add_u32 s14, s79, 32768
    s_mov_b32 m0, s14
    s_add_u32 s15, s79, 131072
    buffer_load_dwordx4 v208, s[52:55], s15 offen offset:0 nt lds
    buffer_load_dwordx4 v209, s[52:55], s15 offen offset:1024 nt lds
    buffer_load_dwordx4 v210, s[52:55], s15 offen offset:2048 nt lds
    buffer_load_dwordx4 v211, s[52:55], s15 offen offset:3072 nt lds
    s_add_u32 s14, s79, 81920
    s_mov_b32 m0, s14
    s_nop 0
    buffer_load_dwordx4 v212, s[56:59], s15 offen offset:0 nt lds
    buffer_load_dwordx4 v212, s[56:59], s15 offen offset:1024 nt lds
    buffer_load_dwordx4 v212, s[56:59], s15 offen offset:2048 nt lds
    buffer_load_dwordx4 v212, s[56:59], s15 offen offset:3072 nt lds
    s_waitcnt vmcnt(24)
    ds_read_b64_tr_b16 v[80:81], v12 offset:0
    ds_read_b64_tr_b16 v[82:83], v12 offset:512
    ds_read_b64_tr_b16 v[84:85], v13 offset:0
    ds_read_b64_tr_b16 v[86:87], v13 offset:512
    ds_read_b64_tr_b16 v[88:89], v12 offset:2048
    ds_read_b64_tr_b16 v[90:91], v12 offset:2560
    ds_read_b64_tr_b16 v[92:93], v13 offset:2048
    ds_read_b64_tr_b16 v[94:95], v13 offset:2560
    ds_read_b64_tr_b16 v[96:97], v12 offset:4096
    ds_read_b64_tr_b16 v[98:99], v12 offset:4608
    ds_read_b64_tr_b16 v[100:101], v13 offset:4096
    ds_read_b64_tr_b16 v[102:103], v13 offset:4608
    ds_read_b64_tr_b16 v[104:105], v12 offset:6144
    ds_read_b64_tr_b16 v[106:107], v12 offset:6656
    ds_read_b64_tr_b16 v[108:109], v13 offset:6144
    s_waitcnt lgkmcnt(14)
    ds_read_b64_tr_b16 v[110:111], v13 offset:6656
    s_waitcnt lgkmcnt(0)
    s_waitcnt vmcnt(16)
    s_barrier
    s_add_u32 s14, s79, 0
    s_mov_b32 m0, s14
    s_add_u32 s15, s79, 147456
    buffer_load_dwordx4 v208, s[52:55], s15 offen offset:0 nt lds
    buffer_load_dwordx4 v209, s[52:55], s15 offen offset:1024 nt lds
    buffer_load_dwordx4 v210, s[52:55], s15 offen offset:2048 nt lds
    buffer_load_dwordx4 v211, s[52:55], s15 offen offset:3072 nt lds
    s_add_u32 s14, s79, 49152
    s_mov_b32 m0, s14
    s_nop 0
    buffer_load_dwordx4 v212, s[56:59], s15 offen offset:0 nt lds
    buffer_load_dwordx4 v212, s[56:59], s15 offen offset:1024 nt lds
    buffer_load_dwordx4 v212, s[56:59], s15 offen offset:2048 nt lds
    buffer_load_dwordx4 v212, s[56:59], s15 offen offset:3072 nt lds
    s_waitcnt vmcnt(16)
    ds_read_b64_tr_b16 v[112:113], v12 offset:8192
    ds_read_b64_tr_b16 v[114:115], v12 offset:8704
    ds_read_b64_tr_b16 v[116:117], v13 offset:8192
    ds_read_b64_tr_b16 v[118:119], v13 offset:8704
    ds_read_b64_tr_b16 v[120:121], v12 offset:10240
    ds_read_b64_tr_b16 v[122:123], v12 offset:10752
    ds_read_b64_tr_b16 v[124:125], v13 offset:10240
    ds_read_b64_tr_b16 v[126:127], v13 offset:10752
    ds_read_b64_tr_b16 v[128:129], v12 offset:12288
    ds_read_b64_tr_b16 v[130:131], v12 offset:12800
    ds_read_b64_tr_b16 v[132:133], v13 offset:12288
    ds_read_b64_tr_b16 v[134:135], v13 offset:12800
    ds_read_b64_tr_b16 v[136:137], v12 offset:14336
    ds_read_b64_tr_b16 v[138:139], v12 offset:14848
    ds_read_b64_tr_b16 v[140:141], v13 offset:14336
    s_waitcnt lgkmcnt(14)
    ds_read_b64_tr_b16 v[142:143], v13 offset:14848
    s_waitcnt lgkmcnt(0)
    s_add_u32 s14, s42, 0
    s_mov_b32 m0, s14
    s_mov_b32 s15, 262144
    buffer_load_dwordx4 v213, s[60:63], s15 offen offset:0 nt lds
    s_mov_b32 s15, 269312
    buffer_load_dwordx4 v213, s[60:63], s15 offen offset:1024 nt lds
    s_mov_b32 s15, 276480
    buffer_load_dwordx4 v213, s[60:63], s15 offen offset:2048 nt lds
    s_mov_b32 s15, 283648
    buffer_load_dwordx4 v213, s[60:63], s15 offen offset:3072 nt lds
    s_add_u32 s14, s42, 4096
    s_mov_b32 m0, s14
    s_mov_b32 s15, 294912
    buffer_load_dwordx4 v213, s[60:63], s15 offen offset:0 nt lds
    s_mov_b32 s15, 302080
    buffer_load_dwordx4 v213, s[60:63], s15 offen offset:1024 nt lds
    s_mov_b32 s15, 309248
    buffer_load_dwordx4 v213, s[60:63], s15 offen offset:2048 nt lds
    s_mov_b32 s15, 316416
    buffer_load_dwordx4 v213, s[60:63], s15 offen offset:3072 nt lds
    s_waitcnt vmcnt(16)
    s_barrier
    s_add_u32 s14, s79, 16384
    s_mov_b32 m0, s14
    s_add_u32 s15, s79, 163840
    buffer_load_dwordx4 v208, s[52:55], s15 offen offset:0 nt lds
    buffer_load_dwordx4 v209, s[52:55], s15 offen offset:1024 nt lds
    buffer_load_dwordx4 v210, s[52:55], s15 offen offset:2048 nt lds
    buffer_load_dwordx4 v211, s[52:55], s15 offen offset:3072 nt lds
    s_add_u32 s14, s79, 65536
    s_mov_b32 m0, s14
    s_nop 0
    buffer_load_dwordx4 v212, s[56:59], s15 offen offset:0 nt lds
    buffer_load_dwordx4 v212, s[56:59], s15 offen offset:1024 nt lds
    buffer_load_dwordx4 v212, s[56:59], s15 offen offset:2048 nt lds
    buffer_load_dwordx4 v212, s[56:59], s15 offen offset:3072 nt lds
    s_add_u32 s14, s42, 8192
    s_mov_b32 m0, s14
    s_mov_b32 s15, 327680
    buffer_load_dwordx4 v213, s[60:63], s15 offen offset:0 nt lds
    s_mov_b32 s15, 334848
    buffer_load_dwordx4 v213, s[60:63], s15 offen offset:1024 nt lds
    s_mov_b32 s15, 342016
    buffer_load_dwordx4 v213, s[60:63], s15 offen offset:2048 nt lds
    s_mov_b32 s15, 349184
    buffer_load_dwordx4 v213, s[60:63], s15 offen offset:3072 nt lds
    s_add_u32 s14, s42, 12288
    s_mov_b32 m0, s14
    s_mov_b32 s15, 360448
    buffer_load_dwordx4 v213, s[60:63], s15 offen offset:0 nt lds
    s_mov_b32 s15, 367616
    buffer_load_dwordx4 v213, s[60:63], s15 offen offset:1024 nt lds
    s_mov_b32 s15, 374784
    buffer_load_dwordx4 v213, s[60:63], s15 offen offset:2048 nt lds
    s_mov_b32 s15, 381952
    buffer_load_dwordx4 v213, s[60:63], s15 offen offset:3072 nt lds
    s_waitcnt vmcnt(24)
    s_barrier
    s_add_u32 s14, s79, 32768
    s_mov_b32 m0, s14
    s_add_u32 s15, s79, 180224
    buffer_load_dwordx4 v208, s[52:55], s15 offen offset:0 nt lds
    buffer_load_dwordx4 v209, s[52:55], s15 offen offset:1024 nt lds
    buffer_load_dwordx4 v210, s[52:55], s15 offen offset:2048 nt lds
    buffer_load_dwordx4 v211, s[52:55], s15 offen offset:3072 nt lds
    s_add_u32 s14, s79, 81920
    s_mov_b32 m0, s14
    s_nop 0
    buffer_load_dwordx4 v212, s[56:59], s15 offen offset:0 nt lds
    buffer_load_dwordx4 v212, s[56:59], s15 offen offset:1024 nt lds
    buffer_load_dwordx4 v212, s[56:59], s15 offen offset:2048 nt lds
    buffer_load_dwordx4 v212, s[56:59], s15 offen offset:3072 nt lds
    s_waitcnt vmcnt(24)
    ds_read_b64_tr_b16 v[144:145], v12 offset:0
    ds_read_b64_tr_b16 v[146:147], v12 offset:512
    ds_read_b64_tr_b16 v[148:149], v13 offset:0
    ds_read_b64_tr_b16 v[150:151], v13 offset:512
    ds_read_b64_tr_b16 v[152:153], v12 offset:2048
    ds_read_b64_tr_b16 v[154:155], v12 offset:2560
    ds_read_b64_tr_b16 v[156:157], v13 offset:2048
    ds_read_b64_tr_b16 v[158:159], v13 offset:2560
    ds_read_b64_tr_b16 v[160:161], v12 offset:4096
    ds_read_b64_tr_b16 v[162:163], v12 offset:4608
    ds_read_b64_tr_b16 v[164:165], v13 offset:4096
    ds_read_b64_tr_b16 v[166:167], v13 offset:4608
    ds_read_b64_tr_b16 v[168:169], v12 offset:6144
    ds_read_b64_tr_b16 v[170:171], v12 offset:6656
    ds_read_b64_tr_b16 v[172:173], v13 offset:6144
    s_waitcnt lgkmcnt(14)
    ds_read_b64_tr_b16 v[174:175], v13 offset:6656
    s_waitcnt lgkmcnt(0)
    s_waitcnt vmcnt(16)
    s_barrier
    s_add_u32 s14, s79, 0
    s_mov_b32 m0, s14
    s_add_u32 s15, s79, 196608
    buffer_load_dwordx4 v208, s[52:55], s15 offen offset:0 nt lds
    buffer_load_dwordx4 v209, s[52:55], s15 offen offset:1024 nt lds
    buffer_load_dwordx4 v210, s[52:55], s15 offen offset:2048 nt lds
    buffer_load_dwordx4 v211, s[52:55], s15 offen offset:3072 nt lds
    s_add_u32 s14, s79, 49152
    s_mov_b32 m0, s14
    s_nop 0
    buffer_load_dwordx4 v212, s[56:59], s15 offen offset:0 nt lds
    buffer_load_dwordx4 v212, s[56:59], s15 offen offset:1024 nt lds
    buffer_load_dwordx4 v212, s[56:59], s15 offen offset:2048 nt lds
    buffer_load_dwordx4 v212, s[56:59], s15 offen offset:3072 nt lds
    s_waitcnt vmcnt(16)
    ds_read_b64_tr_b16 v[176:177], v12 offset:8192
    ds_read_b64_tr_b16 v[178:179], v12 offset:8704
    ds_read_b64_tr_b16 v[180:181], v13 offset:8192
    ds_read_b64_tr_b16 v[182:183], v13 offset:8704
    ds_read_b64_tr_b16 v[184:185], v12 offset:10240
    ds_read_b64_tr_b16 v[186:187], v12 offset:10752
    ds_read_b64_tr_b16 v[188:189], v13 offset:10240
    ds_read_b64_tr_b16 v[190:191], v13 offset:10752
    ds_read_b64_tr_b16 v[192:193], v12 offset:12288
    ds_read_b64_tr_b16 v[194:195], v12 offset:12800
    ds_read_b64_tr_b16 v[196:197], v13 offset:12288
    ds_read_b64_tr_b16 v[198:199], v13 offset:12800
    ds_read_b64_tr_b16 v[200:201], v12 offset:14336
    ds_read_b64_tr_b16 v[202:203], v12 offset:14848
    ds_read_b64_tr_b16 v[204:205], v13 offset:14336
    s_waitcnt lgkmcnt(14)
    ds_read_b64_tr_b16 v[206:207], v13 offset:14848
    s_waitcnt lgkmcnt(0)
    s_add_u32 s14, s42, 0
    s_mov_b32 m0, s14
    s_mov_b32 s15, 393216
    buffer_load_dwordx4 v213, s[60:63], s15 offen offset:0 nt lds
    s_mov_b32 s15, 400384
    buffer_load_dwordx4 v213, s[60:63], s15 offen offset:1024 nt lds
    s_mov_b32 s15, 407552
    buffer_load_dwordx4 v213, s[60:63], s15 offen offset:2048 nt lds
    s_mov_b32 s15, 414720
    buffer_load_dwordx4 v213, s[60:63], s15 offen offset:3072 nt lds
    s_add_u32 s14, s42, 4096
    s_mov_b32 m0, s14
    s_mov_b32 s15, 425984
    buffer_load_dwordx4 v213, s[60:63], s15 offen offset:0 nt lds
    s_mov_b32 s15, 433152
    buffer_load_dwordx4 v213, s[60:63], s15 offen offset:1024 nt lds
    s_mov_b32 s15, 440320
    buffer_load_dwordx4 v213, s[60:63], s15 offen offset:2048 nt lds
    s_mov_b32 s15, 447488
    buffer_load_dwordx4 v213, s[60:63], s15 offen offset:3072 nt lds
    s_waitcnt vmcnt(16)
    s_barrier
    s_add_u32 s14, s79, 16384
    s_mov_b32 m0, s14
    s_add_u32 s15, s79, 212992
    buffer_load_dwordx4 v208, s[52:55], s15 offen offset:0 nt lds
    buffer_load_dwordx4 v209, s[52:55], s15 offen offset:1024 nt lds
    buffer_load_dwordx4 v210, s[52:55], s15 offen offset:2048 nt lds
    buffer_load_dwordx4 v211, s[52:55], s15 offen offset:3072 nt lds
    s_add_u32 s14, s79, 65536
    s_mov_b32 m0, s14
    s_nop 0
    buffer_load_dwordx4 v212, s[56:59], s15 offen offset:0 nt lds
    buffer_load_dwordx4 v212, s[56:59], s15 offen offset:1024 nt lds
    buffer_load_dwordx4 v212, s[56:59], s15 offen offset:2048 nt lds
    buffer_load_dwordx4 v212, s[56:59], s15 offen offset:3072 nt lds
    s_add_u32 s14, s42, 8192
    s_mov_b32 m0, s14
    s_mov_b32 s15, 458752
    buffer_load_dwordx4 v213, s[60:63], s15 offen offset:0 nt lds
    s_mov_b32 s15, 465920
    buffer_load_dwordx4 v213, s[60:63], s15 offen offset:1024 nt lds
    s_mov_b32 s15, 473088
    buffer_load_dwordx4 v213, s[60:63], s15 offen offset:2048 nt lds
    s_mov_b32 s15, 480256
    buffer_load_dwordx4 v213, s[60:63], s15 offen offset:3072 nt lds
    s_add_u32 s14, s42, 12288
    s_mov_b32 m0, s14
    s_mov_b32 s15, 491520
    buffer_load_dwordx4 v213, s[60:63], s15 offen offset:0 nt lds
    s_mov_b32 s15, 498688
    buffer_load_dwordx4 v213, s[60:63], s15 offen offset:1024 nt lds
    s_mov_b32 s15, 505856
    buffer_load_dwordx4 v213, s[60:63], s15 offen offset:2048 nt lds
    s_mov_b32 s15, 513024
    buffer_load_dwordx4 v213, s[60:63], s15 offen offset:3072 nt lds
    s_waitcnt vmcnt(24)
    s_barrier
    s_add_u32 s14, s79, 32768
    s_mov_b32 m0, s14
    s_add_u32 s15, s79, 229376
    buffer_load_dwordx4 v208, s[52:55], s15 offen offset:0 nt lds
    buffer_load_dwordx4 v209, s[52:55], s15 offen offset:1024 nt lds
    buffer_load_dwordx4 v210, s[52:55], s15 offen offset:2048 nt lds
    buffer_load_dwordx4 v211, s[52:55], s15 offen offset:3072 nt lds
    s_add_u32 s14, s79, 81920
    s_mov_b32 m0, s14
    s_nop 0
    buffer_load_dwordx4 v212, s[56:59], s15 offen offset:0 nt lds
    buffer_load_dwordx4 v212, s[56:59], s15 offen offset:1024 nt lds
    buffer_load_dwordx4 v212, s[56:59], s15 offen offset:2048 nt lds
    buffer_load_dwordx4 v212, s[56:59], s15 offen offset:3072 nt lds
    s_waitcnt vmcnt(16)
    s_barrier
    s_add_u32 s14, s79, 0
    s_mov_b32 m0, s14
    s_add_u32 s15, s79, 245760
    buffer_load_dwordx4 v208, s[52:55], s15 offen offset:0 nt lds
    buffer_load_dwordx4 v209, s[52:55], s15 offen offset:1024 nt lds
    buffer_load_dwordx4 v210, s[52:55], s15 offen offset:2048 nt lds
    buffer_load_dwordx4 v211, s[52:55], s15 offen offset:3072 nt lds
    s_add_u32 s14, s79, 49152
    s_mov_b32 m0, s14
    s_nop 0
    buffer_load_dwordx4 v212, s[56:59], s15 offen offset:0 nt lds
    buffer_load_dwordx4 v212, s[56:59], s15 offen offset:1024 nt lds
    buffer_load_dwordx4 v212, s[56:59], s15 offen offset:2048 nt lds
    buffer_load_dwordx4 v212, s[56:59], s15 offen offset:3072 nt lds
    s_waitcnt vmcnt(8)
    s_barrier
    s_waitcnt vmcnt(0)
    s_barrier
    s_waitcnt vmcnt(0)
    s_barrier
    s_barrier
    ds_read_b128 v[240:243], v14 offset:0
    s_waitcnt lgkmcnt(0)
    ds_read_b128 v[244:247], v14 offset:1024
    v_mfma_f32_32x32x16_bf16 v[208:223], v[16:19], v[240:243], 0
    v_mfma_f32_32x32x16_bf16 v[224:239], v[20:23], v[240:243], 0
    s_waitcnt lgkmcnt(0)
    ds_read_b128 v[240:243], v14 offset:2048
    v_mfma_f32_32x32x16_bf16 v[208:223], v[24:27], v[244:247], v[208:223]
    v_mfma_f32_32x32x16_bf16 v[224:239], v[28:31], v[244:247], v[224:239]
    s_waitcnt lgkmcnt(0)
    ds_read_b128 v[244:247], v14 offset:3072
    v_mfma_f32_32x32x16_bf16 v[208:223], v[32:35], v[240:243], v[208:223]
    v_mfma_f32_32x32x16_bf16 v[224:239], v[36:39], v[240:243], v[224:239]
    s_waitcnt lgkmcnt(0)
    ds_read_b128 v[240:243], v14 offset:4096
    v_mfma_f32_32x32x16_bf16 v[208:223], v[40:43], v[244:247], v[208:223]
    v_mfma_f32_32x32x16_bf16 v[224:239], v[44:47], v[244:247], v[224:239]
    s_waitcnt lgkmcnt(0)
    ds_read_b128 v[244:247], v14 offset:5120
    v_mfma_f32_32x32x16_bf16 v[208:223], v[48:51], v[240:243], v[208:223]
    v_mfma_f32_32x32x16_bf16 v[224:239], v[52:55], v[240:243], v[224:239]
    s_waitcnt lgkmcnt(0)
    ds_read_b128 v[240:243], v14 offset:6144
    v_mfma_f32_32x32x16_bf16 v[208:223], v[56:59], v[244:247], v[208:223]
    v_mfma_f32_32x32x16_bf16 v[224:239], v[60:63], v[244:247], v[224:239]
    s_waitcnt lgkmcnt(0)
    ds_read_b128 v[244:247], v14 offset:7168
    v_mfma_f32_32x32x16_bf16 v[208:223], v[64:67], v[240:243], v[208:223]
    v_mfma_f32_32x32x16_bf16 v[224:239], v[68:71], v[240:243], v[224:239]
    s_waitcnt lgkmcnt(0)
    ds_read_b128 v[240:243], v14 offset:8192
    v_mfma_f32_32x32x16_bf16 v[208:223], v[72:75], v[244:247], v[208:223]
    v_mfma_f32_32x32x16_bf16 v[224:239], v[76:79], v[244:247], v[224:239]
    s_waitcnt lgkmcnt(0)
    ds_read_b128 v[244:247], v14 offset:9216
    v_mfma_f32_32x32x16_bf16 v[208:223], v[80:83], v[240:243], v[208:223]
    v_mfma_f32_32x32x16_bf16 v[224:239], v[84:87], v[240:243], v[224:239]
    s_waitcnt lgkmcnt(0)
    ds_read_b128 v[240:243], v14 offset:10240
    v_mfma_f32_32x32x16_bf16 v[208:223], v[88:91], v[244:247], v[208:223]
    v_mfma_f32_32x32x16_bf16 v[224:239], v[92:95], v[244:247], v[224:239]
    s_waitcnt lgkmcnt(0)
    ds_read_b128 v[244:247], v14 offset:11264
    v_mfma_f32_32x32x16_bf16 v[208:223], v[96:99], v[240:243], v[208:223]
    v_mfma_f32_32x32x16_bf16 v[224:239], v[100:103], v[240:243], v[224:239]
    s_waitcnt lgkmcnt(0)
    ds_read_b128 v[240:243], v14 offset:12288
    v_mfma_f32_32x32x16_bf16 v[208:223], v[104:107], v[244:247], v[208:223]
    v_mfma_f32_32x32x16_bf16 v[224:239], v[108:111], v[244:247], v[224:239]
    s_waitcnt lgkmcnt(0)
    ds_read_b128 v[244:247], v14 offset:13312
    v_mfma_f32_32x32x16_bf16 v[208:223], v[112:115], v[240:243], v[208:223]
    v_mfma_f32_32x32x16_bf16 v[224:239], v[116:119], v[240:243], v[224:239]
    s_waitcnt lgkmcnt(0)
    ds_read_b128 v[240:243], v14 offset:14336
    v_mfma_f32_32x32x16_bf16 v[208:223], v[120:123], v[244:247], v[208:223]
    v_mfma_f32_32x32x16_bf16 v[224:239], v[124:127], v[244:247], v[224:239]
    s_waitcnt lgkmcnt(0)
    ds_read_b128 v[244:247], v14 offset:15360
    v_mfma_f32_32x32x16_bf16 v[208:223], v[128:131], v[240:243], v[208:223]
    v_mfma_f32_32x32x16_bf16 v[224:239], v[132:135], v[240:243], v[224:239]
    s_waitcnt lgkmcnt(0)
    ds_read_b128 v[240:243], v14 offset:16384
    v_mfma_f32_32x32x16_bf16 v[208:223], v[136:139], v[244:247], v[208:223]
    v_mfma_f32_32x32x16_bf16 v[224:239], v[140:143], v[244:247], v[224:239]
    s_waitcnt lgkmcnt(0)
    ds_read_b128 v[244:247], v14 offset:17408
    v_mfma_f32_32x32x16_bf16 v[208:223], v[144:147], v[240:243], v[208:223]
    v_mfma_f32_32x32x16_bf16 v[224:239], v[148:151], v[240:243], v[224:239]
    s_waitcnt lgkmcnt(0)
    ds_read_b128 v[240:243], v14 offset:18432
    v_mfma_f32_32x32x16_bf16 v[208:223], v[152:155], v[244:247], v[208:223]
    v_mfma_f32_32x32x16_bf16 v[224:239], v[156:159], v[244:247], v[224:239]
    s_waitcnt lgkmcnt(0)
    ds_read_b128 v[244:247], v14 offset:19456
    v_mfma_f32_32x32x16_bf16 v[208:223], v[160:163], v[240:243], v[208:223]
    v_mfma_f32_32x32x16_bf16 v[224:239], v[164:167], v[240:243], v[224:239]
    s_waitcnt lgkmcnt(0)
    ds_read_b128 v[240:243], v14 offset:20480
    v_mfma_f32_32x32x16_bf16 v[208:223], v[168:171], v[244:247], v[208:223]
    v_mfma_f32_32x32x16_bf16 v[224:239], v[172:175], v[244:247], v[224:239]
    s_waitcnt lgkmcnt(0)
    ds_read_b128 v[244:247], v14 offset:21504
    v_mfma_f32_32x32x16_bf16 v[208:223], v[176:179], v[240:243], v[208:223]
    v_mfma_f32_32x32x16_bf16 v[224:239], v[180:183], v[240:243], v[224:239]
    s_waitcnt lgkmcnt(0)
    ds_read_b128 v[240:243], v14 offset:22528
    v_mfma_f32_32x32x16_bf16 v[208:223], v[184:187], v[244:247], v[208:223]
    v_mfma_f32_32x32x16_bf16 v[224:239], v[188:191], v[244:247], v[224:239]
    s_waitcnt lgkmcnt(0)
    ds_read_b128 v[244:247], v14 offset:23552
    v_mfma_f32_32x32x16_bf16 v[208:223], v[192:195], v[240:243], v[208:223]
    v_mfma_f32_32x32x16_bf16 v[224:239], v[196:199], v[240:243], v[224:239]
    s_waitcnt lgkmcnt(0)
    ds_read_b128 v[240:243], v14 offset:24576
    v_mfma_f32_32x32x16_bf16 v[208:223], v[200:203], v[244:247], v[208:223]
    v_mfma_f32_32x32x16_bf16 v[224:239], v[204:207], v[244:247], v[224:239]
    ds_read_b64_tr_b16 v[248:249], v12 offset:0
    ds_read_b64_tr_b16 v[250:251], v12 offset:512
    ds_read_b64_tr_b16 v[252:253], v13 offset:0
    ds_read_b64_tr_b16 v[254:255], v13 offset:512
    s_waitcnt lgkmcnt(0)
    ds_read_b128 v[244:247], v14 offset:25600
    v_mfma_f32_32x32x16_bf16 v[208:223], v[248:251], v[240:243], v[208:223]
    v_mfma_f32_32x32x16_bf16 v[224:239], v[252:255], v[240:243], v[224:239]
    ds_read_b64_tr_b16 v[248:249], v12 offset:2048
    ds_read_b64_tr_b16 v[250:251], v12 offset:2560
    ds_read_b64_tr_b16 v[252:253], v13 offset:2048
    ds_read_b64_tr_b16 v[254:255], v13 offset:2560
    s_waitcnt lgkmcnt(0)
    ds_read_b128 v[240:243], v14 offset:26624
    v_mfma_f32_32x32x16_bf16 v[208:223], v[248:251], v[244:247], v[208:223]
    v_mfma_f32_32x32x16_bf16 v[224:239], v[252:255], v[244:247], v[224:239]
    ds_read_b64_tr_b16 v[248:249], v12 offset:4096
    ds_read_b64_tr_b16 v[250:251], v12 offset:4608
    ds_read_b64_tr_b16 v[252:253], v13 offset:4096
    ds_read_b64_tr_b16 v[254:255], v13 offset:4608
    s_waitcnt lgkmcnt(0)
    ds_read_b128 v[244:247], v14 offset:27648
    v_mfma_f32_32x32x16_bf16 v[208:223], v[248:251], v[240:243], v[208:223]
    v_mfma_f32_32x32x16_bf16 v[224:239], v[252:255], v[240:243], v[224:239]
    ds_read_b64_tr_b16 v[248:249], v12 offset:6144
    ds_read_b64_tr_b16 v[250:251], v12 offset:6656
    ds_read_b64_tr_b16 v[252:253], v13 offset:6144
    ds_read_b64_tr_b16 v[254:255], v13 offset:6656
    s_waitcnt lgkmcnt(0)
    ds_read_b128 v[240:243], v14 offset:28672
    v_mfma_f32_32x32x16_bf16 v[208:223], v[248:251], v[244:247], v[208:223]
    v_mfma_f32_32x32x16_bf16 v[224:239], v[252:255], v[244:247], v[224:239]
    ds_read_b64_tr_b16 v[248:249], v12 offset:8192
    ds_read_b64_tr_b16 v[250:251], v12 offset:8704
    ds_read_b64_tr_b16 v[252:253], v13 offset:8192
    ds_read_b64_tr_b16 v[254:255], v13 offset:8704
    s_waitcnt lgkmcnt(0)
    ds_read_b128 v[244:247], v14 offset:29696
    v_mfma_f32_32x32x16_bf16 v[208:223], v[248:251], v[240:243], v[208:223]
    v_mfma_f32_32x32x16_bf16 v[224:239], v[252:255], v[240:243], v[224:239]
    ds_read_b64_tr_b16 v[248:249], v12 offset:10240
    ds_read_b64_tr_b16 v[250:251], v12 offset:10752
    ds_read_b64_tr_b16 v[252:253], v13 offset:10240
    ds_read_b64_tr_b16 v[254:255], v13 offset:10752
    s_waitcnt lgkmcnt(0)
    ds_read_b128 v[240:243], v14 offset:30720
    v_mfma_f32_32x32x16_bf16 v[208:223], v[248:251], v[244:247], v[208:223]
    v_mfma_f32_32x32x16_bf16 v[224:239], v[252:255], v[244:247], v[224:239]
    ds_read_b64_tr_b16 v[248:249], v12 offset:12288
    ds_read_b64_tr_b16 v[250:251], v12 offset:12800
    ds_read_b64_tr_b16 v[252:253], v13 offset:12288
    ds_read_b64_tr_b16 v[254:255], v13 offset:12800
    s_waitcnt lgkmcnt(0)
    ds_read_b128 v[244:247], v14 offset:31744
    v_mfma_f32_32x32x16_bf16 v[208:223], v[248:251], v[240:243], v[208:223]
    v_mfma_f32_32x32x16_bf16 v[224:239], v[252:255], v[240:243], v[224:239]
    ds_read_b64_tr_b16 v[248:249], v12 offset:14336
    ds_read_b64_tr_b16 v[250:251], v12 offset:14848
    ds_read_b64_tr_b16 v[252:253], v13 offset:14336
    ds_read_b64_tr_b16 v[254:255], v13 offset:14848
    s_waitcnt lgkmcnt(0)
    v_mfma_f32_32x32x16_bf16 v[208:223], v[248:251], v[244:247], v[208:223]
    v_mfma_f32_32x32x16_bf16 v[224:239], v[252:255], v[244:247], v[224:239]
    s_nop 15
    v_cvt_pk_bf16_f32 v16, v208, v209
    v_cvt_pk_bf16_f32 v17, v210, v211
    v_cvt_pk_bf16_f32 v18, v212, v213
    v_cvt_pk_bf16_f32 v19, v214, v215
    v_cvt_pk_bf16_f32 v20, v216, v217
    v_cvt_pk_bf16_f32 v21, v218, v219
    v_cvt_pk_bf16_f32 v22, v220, v221
    v_cvt_pk_bf16_f32 v23, v222, v223
    v_cvt_pk_bf16_f32 v24, v224, v225
    v_cvt_pk_bf16_f32 v25, v226, v227
    v_cvt_pk_bf16_f32 v26, v228, v229
    v_cvt_pk_bf16_f32 v27, v230, v231
    v_cvt_pk_bf16_f32 v28, v232, v233
    v_cvt_pk_bf16_f32 v29, v234, v235
    v_cvt_pk_bf16_f32 v30, v236, v237
    v_cvt_pk_bf16_f32 v31, v238, v239
    s_lshl_b32 s14, s4, 3
    s_add_u32 s14, s14, s8
    s_lshl_b32 s14, s14, 1
    s_add_u32 s14, s14, s9
    s_lshl_b32 s14, s14, 3
    s_lshl_b32 s15, s78, 1
    s_add_u32 s14, s14, s15
    s_lshl_b32 s14, s14, 3
    s_add_u32 s14, s14, s7
    s_lshl_b32 s15, s14, 11
    s_add_u32 s15, s15, 0x1000000
    s_add_u32 s43, s15, 16384
    v_lshlrev_b32 v9, 4, v1
    buffer_store_dwordx4 v[16:19], v9, s[64:67], s15 offen offset:0 sc0 sc1
    buffer_store_dwordx4 v[20:23], v9, s[64:67], s15 offen offset:1024 sc0 sc1
    buffer_store_dwordx4 v[24:27], v9, s[64:67], s43 offen offset:0 sc0 sc1
    buffer_store_dwordx4 v[28:31], v9, s[64:67], s43 offen offset:1024 sc0 sc1
    s_waitcnt vmcnt(0)
    s_lshl_b32 s15, s14, 8
    s_add_u32 s15, s15, 0x1880000
    v_lshlrev_b32 v10, 11, v1
    v_add_u32 v10, s15, v10
    v_mov_b32 v12, s12
    v_mov_b32 v13, s13
    s_mov_b64 exec, 0x3
    global_store_dwordx2 v10, v[12:13], s[40:41] sc0 sc1
    s_mov_b64 exec, -1
L_FIN:
L_END:
    s_endpgm
.section .rodata,"a"
.p2align 6
.amdhsa_kernel concat_heads__gqa_block_cached__gqa_block_cached__near_ridge_kernel
  .amdhsa_next_free_vgpr 256
  .amdhsa_next_free_sgpr 102
  .amdhsa_accum_offset 256
  .amdhsa_group_segment_fixed_size 0
  .amdhsa_kernarg_size 104
  .amdhsa_user_sgpr_count 2
  .amdhsa_user_sgpr_kernarg_segment_ptr 1
  .amdhsa_system_sgpr_workgroup_id_x 1
.end_amdhsa_kernel
```
